```python
import torch

def _softmax(x, axis=-1):
    return torch.softmax(x, dim=axis)
def _gelu(x):
    return torch.nn.functional.gelu(x, approximate="tanh")
def _silu(x):
    return torch.nn.functional.silu(x)
def _sigmoid(x):
    return torch.sigmoid(x)
def _layernorm(x, axis=-1, eps=1e-5):
    m = x.mean(dim=axis, keepdim=True)
    v = x.var(dim=axis, keepdim=True, unbiased=False)
    return (x - m) / torch.sqrt(v + eps)
def _scatter_add(tgt, idx, src, axis=0):
    return tgt.clone().index_add_(axis, idx, src)
def _segment_sum(src, seg, n):
    out = torch.zeros((n,) + src.shape[1:], dtype=src.dtype)
    return out.index_add_(0, seg, src)
def _pad(x, pw):
    flat = tuple(v for pair in reversed(pw) for v in pair)
    return torch.nn.functional.pad(x, flat)

kernel_name = 'standalone__gqa_softmax__sampling'

def setup_inputs():

    _w = (lambda a: (lambda t: t.to(torch.bfloat16) if t.is_floating_point() else t)(torch.as_tensor(a)))
    B, Hq, Hkv, Sq, Sk, D = 32, 32, 4, 4, 2048, 128
    return {
        "q": _w((lambda *s: torch.randn(*s, dtype=torch.bfloat16) * 0.8)(B, Hq, Sq, D)),
        "k": _w((lambda *s: torch.randn(*s, dtype=torch.bfloat16) * 0.8)(B, Hkv, Sk, D)),
        "v": _w((lambda *s: torch.randn(*s, dtype=torch.bfloat16) * 0.05)(B, Hkv, Sk, D)),
    }

def reference(q, k, v):
    B, Hq, Sq, D = q.shape
    Hkv = k.shape[1]
    rep = Hq // Hkv
    k = (lambda x, n, axis: torch.repeat_interleave(x, n, dim=axis))(k, rep, axis=1)
    v = (lambda x, n, axis: torch.repeat_interleave(x, n, dim=axis))(v, rep, axis=1)
    scale = D ** -0.5
    scores = torch.einsum("bhqd,bhkd->bhqk", q, k) * scale
    p = _softmax(scores, axis=-1)
    return torch.einsum("bhqk,bhkd->bhqd", p, v)
```

```asm
; @launch grid=(256,1,1) block=(256,1,1) lds=156672
.amdgcn_target "amdgcn-amd-amdhsa--gfx950"
.text
.globl standalone__gqa_softmax__sampling_kernel
.p2align 8
.type standalone__gqa_softmax__sampling_kernel,@function
standalone__gqa_softmax__sampling_kernel:
    s_cmp_ge_u32 s2, 256
    s_cbranch_scc1 L_end2
    s_load_dwordx8 s[4:11], s[0:1], 0
    s_load_dwordx4 s[12:15], s[0:1], 32
    v_lshrrev_b32 v1, 6, v0
    v_bfe_u32 v2, v0, 4, 2
    v_readfirstlane_b32 s3, v1
    v_and_b32 v3, 15, v0
    v_xor_b32 v4, v3, v2
    v_lshl_add_u32 v5, v1, 4, v2
    v_lshl_add_u32 v5, v5, 4, v4
    v_lshlrev_b32 v224, 4, v5
    s_and_b32 s16, s2, 7
    s_lshl_b32 s16, s16, 4
    s_lshr_b32 s17, s2, 4
    s_or_b32 s16, s16, s17
    s_bfe_u32 s17, s2, 0x10003
    s_xor_b32 s18, s2, 8
    s_lshl_b32 s48, s16, 1
    s_add_u32 s48, s48, s17
    s_lshl_b32 s48, s48, 18
    s_bfe_u32 s86, s2, 65541
    s_lshl_b32 s86, s86, 17
    s_lshl_b32 s44, s3, 14
    s_lshl_b32 s53, s16, 13
    s_lshl_b32 s52, s3, 11
    s_add_u32 m0, s52, 147456
    v_lshl_add_u32 v6, v1, 3, v2
    v_and_b32 v7, 15, v6
    v_xor_b32 v7, v7, v3
    v_lshlrev_b32 v6, 8, v6
    v_lshl_add_u32 v244, v7, 4, v6
    v_xor_b32 v245, 64, v244
    s_mov_b32 s30, 8192
    s_mov_b32 s31, 0x20000
    v_xor_b32 v225, 64, v224
    v_xor_b32 v226, 128, v224
    v_xor_b32 v227, 192, v224
    s_mov_b32 s22, 0x40000
    s_mov_b32 s23, 0x20000
    s_waitcnt lgkmcnt(0)
    s_add_u32 s28, s4, s53
    s_addc_u32 s29, s5, 0
    s_add_u32 s20, s6, s48
    s_addc_u32 s21, s7, 0
    buffer_load_dwordx4 v244, s[28:31], 0 offen offset:0 nt lds
    buffer_load_dwordx4 v245, s[28:31], 0 offen offset:1024 nt lds
    s_add_u32 m0, s44, 0
    s_xor_b32 s40, s86, 0
    buffer_load_dwordx4 v224, s[20:23], s40 offen offset:0 nt lds
    buffer_load_dwordx4 v225, s[20:23], s40 offen offset:1024 nt lds
    buffer_load_dwordx4 v226, s[20:23], s40 offen offset:2048 nt lds
    buffer_load_dwordx4 v227, s[20:23], s40 offen offset:3072 nt lds
    s_mov_b32 s36, s14
    s_mov_b32 s37, s15
    s_mov_b32 s38, 1179648
    s_mov_b32 s39, 0x20000
    s_mov_b32 s96, s14
    s_mov_b32 s97, s15
    s_mov_b32 s99, 0x20000
    s_lshl_b32 s54, s2, 8
    s_add_u32 s54, s54, 1114112
    s_lshl_b32 s55, s18, 8
    s_add_u32 s55, s55, 1114112
    buffer_load_dwordx4 v[200:203], off, s[36:39], s54 sc1
    buffer_load_dwordx4 v[204:207], off, s[36:39], s55 sc1
    s_getreg_b32 s41, hwreg(HW_REG_XCC_ID)
    v_and_b32 v241, 63, v0
    v_and_b32 v4, 31, v0
    v_bfe_u32 v5, v0, 5, 1
    v_xor_b32 v6, v3, v5
    v_lshlrev_b32 v7, 8, v4
    v_add_u32 v7, 147456, v7
    v_lshl_add_u32 v216, v6, 4, v7
    v_xor_b32 v217, 32, v216
    v_xor_b32 v218, 64, v216
    v_xor_b32 v219, 96, v216
    v_xor_b32 v220, 128, v216
    v_xor_b32 v221, 160, v216
    v_xor_b32 v222, 192, v216
    v_xor_b32 v223, 224, v216
    v_lshlrev_b32 v7, 4, v4
    v_add_u32 v242, 155648, v7
    v_lshl_add_u32 v243, v1, 2, v242
    s_add_u32 s24, s8, s48
    s_addc_u32 s25, s9, 0
    s_mov_b32 s26, 0x40000
    s_mov_b32 s27, 0x20000
    s_sub_u32 s88, s24, 2048
    s_subb_u32 s89, s25, 0
    s_mov_b32 s90, 0x40800
    s_mov_b32 s91, 0x20000
    v_bfe_u32 v4, v0, 3, 3
    v_lshlrev_b32 v6, 1, v2
    v_and_b32 v7, 7, v0
    v_xor_b32 v6, v6, v7
    v_lshl_add_u32 v4, v1, 4, v4
    v_lshlrev_b32 v4, 8, v4
    v_lshl_add_u32 v4, v6, 4, v4
    s_mov_b32 s49, s17
    s_bfe_u32 s87, s2, 65542
    s_xor_b32 s49, s49, s87
    s_lshl_b32 s49, s49, 7
    v_add_u32 v230, s49, v4
    v_xor_b32 v228, 0x80, v230
    v_add_u32 v229, 1024, v228
    v_add_u32 v231, 1024, v230
    s_lshl_b32 s57, s3, 12
    s_add_u32 s45, s57, 65536
    v_bfe_u32 v4, v0, 2, 2
    v_bfe_u32 v6, v0, 4, 1
    v_lshl_add_u32 v7, v6, 2, v4
    v_lshl_add_u32 v232, v5, 4, v7
    v_lshlrev_b32 v232, 7, v232
    v_lshrrev_b32 v7, 1, v7
    v_xor_b32 v7, v7, v1
    v_lshl_add_u32 v232, v7, 5, v232
    v_and_b32 v7, 3, v0
    v_lshl_add_u32 v232, v7, 3, v232
    v_add_u32 v232, 65536, v232
    v_add_u32 v233, 0x10000, v232
    v_lshlrev_b32 v235, 4, v0
    v_lshl_add_u32 v7, v6, 5, v3
    v_lshlrev_b32 v7, 4, v7
    v_lshl_add_u32 v234, v5, 12, v7
    v_mov_b32 v236, 0xff800000
    s_mov_b32 s46, 0x3e0293ee
    s_sub_u32 s56, s44, 147456
    s_add_u32 s32, s10, s53
    s_addc_u32 s33, s11, 0
    s_mov_b32 s34, 8192
    s_mov_b32 s35, 0x20000
    s_lshl_b32 s47, s3, 10
    s_lshl_b32 s58, s2, 12
    s_add_u32 s58, s58, s47
    s_lshl_b32 s59, s18, 12
    s_add_u32 s59, s59, s47
    s_lshl_b32 s43, s2, 8
    s_add_u32 s43, s43, 1046528
    s_lshl_b32 s19, s18, 8
    s_add_u32 s19, s19, 1046528
    s_mov_b32 s62, 0
    s_waitcnt vmcnt(7)
    s_add_u32 m0, s44, 4096
    s_xor_b32 s40, s86, 16384
    buffer_load_dwordx4 v224, s[20:23], s40 offen offset:0 nt lds
    s_waitcnt vmcnt(7)
    buffer_load_dwordx4 v225, s[20:23], s40 offen offset:1024 nt lds
    s_barrier
    ds_read_b128 v[8:11], v216
    ds_read_b128 v[12:15], v217
    ds_read_b128 v[16:19], v218
    ds_read_b128 v[20:23], v219
    ds_read_b128 v[24:27], v220
    ds_read_b128 v[28:31], v221
    ds_read_b128 v[32:35], v222
    ds_read_b128 v[36:39], v223
    v_add_u32 v216, s56, v216
    v_add_u32 v217, s56, v217
    v_add_u32 v218, s56, v218
    v_add_u32 v219, s56, v219
    v_add_u32 v220, s56, v220
    v_add_u32 v221, s56, v221
    v_add_u32 v222, s56, v222
    v_add_u32 v223, s56, v223
    s_waitcnt vmcnt(7)
    buffer_load_dwordx4 v226, s[20:23], s40 offen offset:2048 nt lds
    s_waitcnt vmcnt(7)
    buffer_load_dwordx4 v227, s[20:23], s40 offen offset:3072 nt lds
    s_waitcnt vmcnt(7)
    s_add_u32 m0, s44, 8192
    s_xor_b32 s40, s86, 32768
    buffer_load_dwordx4 v224, s[20:23], s40 offen offset:0 nt lds
    s_waitcnt vmcnt(7)
    buffer_load_dwordx4 v225, s[20:23], s40 offen offset:1024 nt lds
    s_waitcnt vmcnt(5)
    buffer_load_dwordx4 v226, s[20:23], s40 offen offset:2048 nt lds
    s_waitcnt vmcnt(5)
    buffer_load_dwordx4 v227, s[20:23], s40 offen offset:3072 nt lds
    s_waitcnt vmcnt(5)
    s_add_u32 m0, s44, 12288
    s_xor_b32 s40, s86, 49152
    buffer_load_dwordx4 v224, s[20:23], s40 offen offset:0 nt lds
    s_waitcnt vmcnt(5)
    buffer_load_dwordx4 v225, s[20:23], s40 offen offset:1024 nt lds
    ds_read_b128 v[168:171], v216 offset:0
    ds_read_b128 v[172:175], v217 offset:0
    ds_read_b128 v[176:179], v218 offset:0
    ds_read_b128 v[180:183], v219 offset:0
    ds_read_b128 v[184:187], v220 offset:0
    ds_read_b128 v[188:191], v221 offset:0
    ds_read_b128 v[192:195], v222 offset:0
    ds_read_b128 v[196:199], v223 offset:0
    s_waitcnt lgkmcnt(7)
    v_mfma_f32_32x32x16_bf16 v[40:55], v[168:171], v[8:11], 0
    s_waitcnt lgkmcnt(6)
    v_mfma_f32_32x32x16_bf16 v[40:55], v[172:175], v[12:15], v[40:55]
    s_waitcnt lgkmcnt(5)
    v_mfma_f32_32x32x16_bf16 v[40:55], v[176:179], v[16:19], v[40:55]
    s_waitcnt lgkmcnt(4)
    v_mfma_f32_32x32x16_bf16 v[40:55], v[180:183], v[20:23], v[40:55]
    s_waitcnt vmcnt(5)
    buffer_load_dwordx4 v226, s[20:23], s40 offen offset:2048 nt lds
    s_waitcnt lgkmcnt(3)
    v_mfma_f32_32x32x16_bf16 v[40:55], v[184:187], v[24:27], v[40:55]
    s_waitcnt lgkmcnt(2)
    v_mfma_f32_32x32x16_bf16 v[40:55], v[188:191], v[28:31], v[40:55]
    s_waitcnt lgkmcnt(1)
    v_mfma_f32_32x32x16_bf16 v[40:55], v[192:195], v[32:35], v[40:55]
    s_waitcnt lgkmcnt(0)
    v_mfma_f32_32x32x16_bf16 v[40:55], v[196:199], v[36:39], v[40:55]
    s_waitcnt vmcnt(5)
    buffer_load_dwordx4 v227, s[20:23], s40 offen offset:3072 nt lds
    s_waitcnt vmcnt(5)
    s_add_u32 m0, s44, 0
    s_xor_b32 s40, s86, 65536
    buffer_load_dwordx4 v224, s[20:23], s40 offen offset:0 nt lds
    s_waitcnt vmcnt(5)
    buffer_load_dwordx4 v225, s[20:23], s40 offen offset:1024 nt lds
    s_waitcnt vmcnt(5)
    buffer_load_dwordx4 v226, s[20:23], s40 offen offset:2048 nt lds
    s_waitcnt vmcnt(5)
    buffer_load_dwordx4 v227, s[20:23], s40 offen offset:3072 nt lds
    s_waitcnt vmcnt(5)
    s_add_u32 m0, s44, 4096
    s_xor_b32 s40, s86, 81920
    buffer_load_dwordx4 v224, s[20:23], s40 offen offset:0 nt lds
    s_waitcnt vmcnt(5)
    buffer_load_dwordx4 v225, s[20:23], s40 offen offset:1024 nt lds
    ds_read_b128 v[168:171], v216 offset:8192
    ds_read_b128 v[172:175], v217 offset:8192
    ds_read_b128 v[176:179], v218 offset:8192
    ds_read_b128 v[180:183], v219 offset:8192
    ds_read_b128 v[184:187], v220 offset:8192
    ds_read_b128 v[188:191], v221 offset:8192
    ds_read_b128 v[192:195], v222 offset:8192
    ds_read_b128 v[196:199], v223 offset:8192
    v_max3_f32 v236, v236, v40, v41
    v_max3_f32 v236, v236, v42, v43
    v_max3_f32 v236, v236, v44, v45
    v_max3_f32 v236, v236, v46, v47
    v_max3_f32 v236, v236, v48, v49
    v_max3_f32 v236, v236, v50, v51
    v_max3_f32 v236, v236, v52, v53
    v_max3_f32 v236, v236, v54, v55
    s_waitcnt lgkmcnt(7)
    v_mfma_f32_32x32x16_bf16 v[56:71], v[168:171], v[8:11], 0
    s_waitcnt lgkmcnt(6)
    v_mfma_f32_32x32x16_bf16 v[56:71], v[172:175], v[12:15], v[56:71]
    s_waitcnt lgkmcnt(5)
    v_mfma_f32_32x32x16_bf16 v[56:71], v[176:179], v[16:19], v[56:71]
    s_waitcnt lgkmcnt(4)
    v_mfma_f32_32x32x16_bf16 v[56:71], v[180:183], v[20:23], v[56:71]
    s_waitcnt vmcnt(5)
    buffer_load_dwordx4 v226, s[20:23], s40 offen offset:2048 nt lds
    s_waitcnt lgkmcnt(3)
    v_mfma_f32_32x32x16_bf16 v[56:71], v[184:187], v[24:27], v[56:71]
    s_waitcnt lgkmcnt(2)
    v_mfma_f32_32x32x16_bf16 v[56:71], v[188:191], v[28:31], v[56:71]
    s_waitcnt lgkmcnt(1)
    v_mfma_f32_32x32x16_bf16 v[56:71], v[192:195], v[32:35], v[56:71]
    s_waitcnt lgkmcnt(0)
    v_mfma_f32_32x32x16_bf16 v[56:71], v[196:199], v[36:39], v[56:71]
    s_waitcnt vmcnt(5)
    buffer_load_dwordx4 v227, s[20:23], s40 offen offset:3072 nt lds
    s_waitcnt vmcnt(5)
    s_add_u32 m0, s44, 8192
    s_xor_b32 s40, s86, 98304
    buffer_load_dwordx4 v224, s[20:23], s40 offen offset:0 nt lds
    s_waitcnt vmcnt(5)
    buffer_load_dwordx4 v225, s[20:23], s40 offen offset:1024 nt lds
    s_waitcnt vmcnt(5)
    buffer_load_dwordx4 v226, s[20:23], s40 offen offset:2048 nt lds
    s_waitcnt vmcnt(5)
    buffer_load_dwordx4 v227, s[20:23], s40 offen offset:3072 nt lds
    s_waitcnt vmcnt(5)
    s_add_u32 m0, s44, 12288
    s_xor_b32 s40, s86, 114688
    buffer_load_dwordx4 v224, s[20:23], s40 offen offset:0 nt lds
    s_waitcnt vmcnt(5)
    buffer_load_dwordx4 v225, s[20:23], s40 offen offset:1024 nt lds
    ds_read_b128 v[168:171], v216 offset:0
    ds_read_b128 v[172:175], v217 offset:0
    ds_read_b128 v[176:179], v218 offset:0
    ds_read_b128 v[180:183], v219 offset:0
    ds_read_b128 v[184:187], v220 offset:0
    ds_read_b128 v[188:191], v221 offset:0
    ds_read_b128 v[192:195], v222 offset:0
    ds_read_b128 v[196:199], v223 offset:0
    v_max3_f32 v236, v236, v56, v57
    v_max3_f32 v236, v236, v58, v59
    v_max3_f32 v236, v236, v60, v61
    v_max3_f32 v236, v236, v62, v63
    v_max3_f32 v236, v236, v64, v65
    v_max3_f32 v236, v236, v66, v67
    v_max3_f32 v236, v236, v68, v69
    v_max3_f32 v236, v236, v70, v71
    v_readfirstlane_b32 s50, v200
    v_readfirstlane_b32 s51, v202
    v_readfirstlane_b32 s60, v204
    v_readfirstlane_b32 s63, v206
    s_waitcnt lgkmcnt(7)
    v_mfma_f32_32x32x16_bf16 v[72:87], v[168:171], v[8:11], 0
    s_waitcnt lgkmcnt(6)
    v_mfma_f32_32x32x16_bf16 v[72:87], v[172:175], v[12:15], v[72:87]
    s_waitcnt lgkmcnt(5)
    v_mfma_f32_32x32x16_bf16 v[72:87], v[176:179], v[16:19], v[72:87]
    s_waitcnt lgkmcnt(4)
    v_mfma_f32_32x32x16_bf16 v[72:87], v[180:183], v[20:23], v[72:87]
    s_waitcnt vmcnt(5)
    buffer_load_dwordx4 v226, s[20:23], s40 offen offset:2048 nt lds
    s_waitcnt lgkmcnt(3)
    v_mfma_f32_32x32x16_bf16 v[72:87], v[184:187], v[24:27], v[72:87]
    s_waitcnt lgkmcnt(2)
    v_mfma_f32_32x32x16_bf16 v[72:87], v[188:191], v[28:31], v[72:87]
    s_waitcnt lgkmcnt(1)
    v_mfma_f32_32x32x16_bf16 v[72:87], v[192:195], v[32:35], v[72:87]
    s_waitcnt lgkmcnt(0)
    v_mfma_f32_32x32x16_bf16 v[72:87], v[196:199], v[36:39], v[72:87]
    s_waitcnt vmcnt(5)
    buffer_load_dwordx4 v227, s[20:23], s40 offen offset:3072 nt lds
    s_waitcnt vmcnt(5)
    s_add_u32 m0, s44, 0
    s_xor_b32 s40, s86, 131072
    buffer_load_dwordx4 v224, s[20:23], s40 offen offset:0 nt lds
    s_waitcnt vmcnt(5)
    buffer_load_dwordx4 v225, s[20:23], s40 offen offset:1024 nt lds
    s_waitcnt vmcnt(5)
    buffer_load_dwordx4 v226, s[20:23], s40 offen offset:2048 nt lds
    s_waitcnt vmcnt(5)
    buffer_load_dwordx4 v227, s[20:23], s40 offen offset:3072 nt lds
    s_waitcnt vmcnt(5)
    s_add_u32 m0, s44, 4096
    s_xor_b32 s40, s86, 147456
    buffer_load_dwordx4 v224, s[20:23], s40 offen offset:0 nt lds
    s_waitcnt vmcnt(5)
    buffer_load_dwordx4 v225, s[20:23], s40 offen offset:1024 nt lds
    ds_read_b128 v[168:171], v216 offset:8192
    ds_read_b128 v[172:175], v217 offset:8192
    ds_read_b128 v[176:179], v218 offset:8192
    ds_read_b128 v[180:183], v219 offset:8192
    ds_read_b128 v[184:187], v220 offset:8192
    ds_read_b128 v[188:191], v221 offset:8192
    ds_read_b128 v[192:195], v222 offset:8192
    ds_read_b128 v[196:199], v223 offset:8192
    v_max3_f32 v236, v236, v72, v73
    v_max3_f32 v236, v236, v74, v75
    v_max3_f32 v236, v236, v76, v77
    v_max3_f32 v236, v236, v78, v79
    v_max3_f32 v236, v236, v80, v81
    v_max3_f32 v236, v236, v82, v83
    v_max3_f32 v236, v236, v84, v85
    v_max3_f32 v236, v236, v86, v87
    s_waitcnt lgkmcnt(7)
    v_mfma_f32_32x32x16_bf16 v[88:103], v[168:171], v[8:11], 0
    s_waitcnt lgkmcnt(6)
    v_mfma_f32_32x32x16_bf16 v[88:103], v[172:175], v[12:15], v[88:103]
    s_waitcnt lgkmcnt(5)
    v_mfma_f32_32x32x16_bf16 v[88:103], v[176:179], v[16:19], v[88:103]
    s_waitcnt lgkmcnt(4)
    v_mfma_f32_32x32x16_bf16 v[88:103], v[180:183], v[20:23], v[88:103]
    s_waitcnt vmcnt(5)
    buffer_load_dwordx4 v226, s[20:23], s40 offen offset:2048 nt lds
    s_waitcnt lgkmcnt(3)
    v_mfma_f32_32x32x16_bf16 v[88:103], v[184:187], v[24:27], v[88:103]
    s_waitcnt lgkmcnt(2)
    v_mfma_f32_32x32x16_bf16 v[88:103], v[188:191], v[28:31], v[88:103]
    s_waitcnt lgkmcnt(1)
    v_mfma_f32_32x32x16_bf16 v[88:103], v[192:195], v[32:35], v[88:103]
    s_waitcnt lgkmcnt(0)
    v_mfma_f32_32x32x16_bf16 v[88:103], v[196:199], v[36:39], v[88:103]
    s_waitcnt vmcnt(5)
    buffer_load_dwordx4 v227, s[20:23], s40 offen offset:3072 nt lds
    s_waitcnt vmcnt(5)
    s_add_u32 m0, s44, 8192
    s_xor_b32 s40, s86, 163840
    buffer_load_dwordx4 v224, s[20:23], s40 offen offset:0 nt lds
    s_waitcnt vmcnt(5)
    buffer_load_dwordx4 v225, s[20:23], s40 offen offset:1024 nt lds
    s_waitcnt vmcnt(5)
    buffer_load_dwordx4 v226, s[20:23], s40 offen offset:2048 nt lds
    s_waitcnt vmcnt(5)
    buffer_load_dwordx4 v227, s[20:23], s40 offen offset:3072 nt lds
    s_waitcnt vmcnt(5)
    s_add_u32 m0, s44, 12288
    s_xor_b32 s40, s86, 180224
    buffer_load_dwordx4 v224, s[20:23], s40 offen offset:0 nt lds
    s_waitcnt vmcnt(5)
    buffer_load_dwordx4 v225, s[20:23], s40 offen offset:1024 nt lds
    ds_read_b128 v[168:171], v216 offset:0
    ds_read_b128 v[172:175], v217 offset:0
    ds_read_b128 v[176:179], v218 offset:0
    ds_read_b128 v[180:183], v219 offset:0
    ds_read_b128 v[184:187], v220 offset:0
    ds_read_b128 v[188:191], v221 offset:0
    ds_read_b128 v[192:195], v222 offset:0
    ds_read_b128 v[196:199], v223 offset:0
    v_max3_f32 v236, v236, v88, v89
    v_max3_f32 v236, v236, v90, v91
    v_max3_f32 v236, v236, v92, v93
    v_max3_f32 v236, v236, v94, v95
    v_max3_f32 v236, v236, v96, v97
    v_max3_f32 v236, v236, v98, v99
    v_max3_f32 v236, v236, v100, v101
    v_max3_f32 v236, v236, v102, v103
    s_waitcnt lgkmcnt(7)
    v_mfma_f32_32x32x16_bf16 v[104:119], v[168:171], v[8:11], 0
    s_waitcnt lgkmcnt(6)
    v_mfma_f32_32x32x16_bf16 v[104:119], v[172:175], v[12:15], v[104:119]
    s_waitcnt lgkmcnt(5)
    v_mfma_f32_32x32x16_bf16 v[104:119], v[176:179], v[16:19], v[104:119]
    s_waitcnt lgkmcnt(4)
    v_mfma_f32_32x32x16_bf16 v[104:119], v[180:183], v[20:23], v[104:119]
    s_waitcnt vmcnt(5)
    buffer_load_dwordx4 v226, s[20:23], s40 offen offset:2048 nt lds
    s_waitcnt lgkmcnt(3)
    v_mfma_f32_32x32x16_bf16 v[104:119], v[184:187], v[24:27], v[104:119]
    s_waitcnt lgkmcnt(2)
    v_mfma_f32_32x32x16_bf16 v[104:119], v[188:191], v[28:31], v[104:119]
    s_waitcnt lgkmcnt(1)
    v_mfma_f32_32x32x16_bf16 v[104:119], v[192:195], v[32:35], v[104:119]
    s_waitcnt lgkmcnt(0)
    v_mfma_f32_32x32x16_bf16 v[104:119], v[196:199], v[36:39], v[104:119]
    s_waitcnt vmcnt(5)
    buffer_load_dwordx4 v227, s[20:23], s40 offen offset:3072 nt lds
    s_waitcnt vmcnt(5)
    s_add_u32 m0, s44, 0
    s_xor_b32 s40, s86, 196608
    buffer_load_dwordx4 v224, s[20:23], s40 offen offset:0 nt lds
    s_waitcnt vmcnt(5)
    buffer_load_dwordx4 v225, s[20:23], s40 offen offset:1024 nt lds
    s_waitcnt vmcnt(5)
    buffer_load_dwordx4 v226, s[20:23], s40 offen offset:2048 nt lds
    s_waitcnt vmcnt(5)
    buffer_load_dwordx4 v227, s[20:23], s40 offen offset:3072 nt lds
    s_waitcnt vmcnt(5)
    s_add_u32 m0, s44, 4096
    s_xor_b32 s40, s86, 212992
    buffer_load_dwordx4 v224, s[20:23], s40 offen offset:0 nt lds
    s_waitcnt vmcnt(5)
    buffer_load_dwordx4 v225, s[20:23], s40 offen offset:1024 nt lds
    ds_read_b128 v[168:171], v216 offset:8192
    ds_read_b128 v[172:175], v217 offset:8192
    ds_read_b128 v[176:179], v218 offset:8192
    ds_read_b128 v[180:183], v219 offset:8192
    ds_read_b128 v[184:187], v220 offset:8192
    ds_read_b128 v[188:191], v221 offset:8192
    ds_read_b128 v[192:195], v222 offset:8192
    ds_read_b128 v[196:199], v223 offset:8192
    v_max3_f32 v236, v236, v104, v105
    v_max3_f32 v236, v236, v106, v107
    v_max3_f32 v236, v236, v108, v109
    v_max3_f32 v236, v236, v110, v111
    v_max3_f32 v236, v236, v112, v113
    v_max3_f32 v236, v236, v114, v115
    v_max3_f32 v236, v236, v116, v117
    v_max3_f32 v236, v236, v118, v119
    s_waitcnt lgkmcnt(7)
    v_mfma_f32_32x32x16_bf16 v[120:135], v[168:171], v[8:11], 0
    s_waitcnt lgkmcnt(6)
    v_mfma_f32_32x32x16_bf16 v[120:135], v[172:175], v[12:15], v[120:135]
    s_waitcnt lgkmcnt(5)
    v_mfma_f32_32x32x16_bf16 v[120:135], v[176:179], v[16:19], v[120:135]
    s_waitcnt lgkmcnt(4)
    v_mfma_f32_32x32x16_bf16 v[120:135], v[180:183], v[20:23], v[120:135]
    s_waitcnt vmcnt(5)
    buffer_load_dwordx4 v226, s[20:23], s40 offen offset:2048 nt lds
    s_waitcnt lgkmcnt(3)
    v_mfma_f32_32x32x16_bf16 v[120:135], v[184:187], v[24:27], v[120:135]
    s_waitcnt lgkmcnt(2)
    v_mfma_f32_32x32x16_bf16 v[120:135], v[188:191], v[28:31], v[120:135]
    s_waitcnt lgkmcnt(1)
    v_mfma_f32_32x32x16_bf16 v[120:135], v[192:195], v[32:35], v[120:135]
    s_waitcnt lgkmcnt(0)
    v_mfma_f32_32x32x16_bf16 v[120:135], v[196:199], v[36:39], v[120:135]
    s_waitcnt vmcnt(5)
    buffer_load_dwordx4 v227, s[20:23], s40 offen offset:3072 nt lds
    s_waitcnt vmcnt(5)
    s_add_u32 m0, s44, 8192
    s_xor_b32 s40, s86, 229376
    buffer_load_dwordx4 v224, s[20:23], s40 offen offset:0 nt lds
    s_waitcnt vmcnt(5)
    buffer_load_dwordx4 v225, s[20:23], s40 offen offset:1024 nt lds
    s_waitcnt vmcnt(5)
    buffer_load_dwordx4 v226, s[20:23], s40 offen offset:2048 nt lds
    s_waitcnt vmcnt(5)
    buffer_load_dwordx4 v227, s[20:23], s40 offen offset:3072 nt lds
    s_waitcnt vmcnt(5)
    s_add_u32 m0, s44, 12288
    s_xor_b32 s40, s86, 245760
    buffer_load_dwordx4 v224, s[20:23], s40 offen offset:0 nt lds
    s_waitcnt vmcnt(5)
    buffer_load_dwordx4 v225, s[20:23], s40 offen offset:1024 nt lds
    ds_read_b128 v[168:171], v216 offset:0
    ds_read_b128 v[172:175], v217 offset:0
    ds_read_b128 v[176:179], v218 offset:0
    ds_read_b128 v[180:183], v219 offset:0
    ds_read_b128 v[184:187], v220 offset:0
    ds_read_b128 v[188:191], v221 offset:0
    ds_read_b128 v[192:195], v222 offset:0
    ds_read_b128 v[196:199], v223 offset:0
    v_max3_f32 v236, v236, v120, v121
    v_max3_f32 v236, v236, v122, v123
    v_max3_f32 v236, v236, v124, v125
    v_max3_f32 v236, v236, v126, v127
    v_max3_f32 v236, v236, v128, v129
    v_max3_f32 v236, v236, v130, v131
    v_max3_f32 v236, v236, v132, v133
    v_max3_f32 v236, v236, v134, v135
    s_waitcnt lgkmcnt(7)
    v_mfma_f32_32x32x16_bf16 v[136:151], v[168:171], v[8:11], 0
    s_waitcnt lgkmcnt(6)
    v_mfma_f32_32x32x16_bf16 v[136:151], v[172:175], v[12:15], v[136:151]
    s_waitcnt lgkmcnt(5)
    v_mfma_f32_32x32x16_bf16 v[136:151], v[176:179], v[16:19], v[136:151]
    s_waitcnt lgkmcnt(4)
    v_mfma_f32_32x32x16_bf16 v[136:151], v[180:183], v[20:23], v[136:151]
    s_waitcnt vmcnt(5)
    buffer_load_dwordx4 v226, s[20:23], s40 offen offset:2048 nt lds
    s_waitcnt lgkmcnt(3)
    v_mfma_f32_32x32x16_bf16 v[136:151], v[184:187], v[24:27], v[136:151]
    s_waitcnt lgkmcnt(2)
    v_mfma_f32_32x32x16_bf16 v[136:151], v[188:191], v[28:31], v[136:151]
    s_waitcnt lgkmcnt(1)
    v_mfma_f32_32x32x16_bf16 v[136:151], v[192:195], v[32:35], v[136:151]
    s_waitcnt lgkmcnt(0)
    v_mfma_f32_32x32x16_bf16 v[136:151], v[196:199], v[36:39], v[136:151]
    s_waitcnt vmcnt(5)
    buffer_load_dwordx4 v227, s[20:23], s40 offen offset:3072 nt lds
    s_waitcnt vmcnt(5)
    s_add_u32 m0, s45, 0
    s_xor_b32 s40, s86, 0
    buffer_load_dwordx4 v228, s[24:27], s40 offen offset:0 nt lds
    s_waitcnt vmcnt(5)
    buffer_load_dwordx4 v229, s[24:27], s40 offen offset:1024 nt lds
    s_waitcnt vmcnt(5)
    s_xor_b32 s40, s86, 16384
    buffer_load_dwordx4 v228, s[88:91], s40 offen offset:2048 nt lds
    s_waitcnt vmcnt(5)
    buffer_load_dwordx4 v229, s[88:91], s40 offen offset:3072 nt lds
    s_waitcnt vmcnt(5)
    s_add_u32 m0, s45, 16384
    s_xor_b32 s40, s86, 32768
    buffer_load_dwordx4 v228, s[24:27], s40 offen offset:0 nt lds
    s_waitcnt vmcnt(5)
    buffer_load_dwordx4 v229, s[24:27], s40 offen offset:1024 nt lds
    ds_read_b128 v[168:171], v216 offset:8192
    ds_read_b128 v[172:175], v217 offset:8192
    ds_read_b128 v[176:179], v218 offset:8192
    ds_read_b128 v[180:183], v219 offset:8192
    ds_read_b128 v[184:187], v220 offset:8192
    ds_read_b128 v[188:191], v221 offset:8192
    ds_read_b128 v[192:195], v222 offset:8192
    ds_read_b128 v[196:199], v223 offset:8192
    v_max3_f32 v236, v236, v136, v137
    v_max3_f32 v236, v236, v138, v139
    v_max3_f32 v236, v236, v140, v141
    v_max3_f32 v236, v236, v142, v143
    v_max3_f32 v236, v236, v144, v145
    v_max3_f32 v236, v236, v146, v147
    v_max3_f32 v236, v236, v148, v149
    v_max3_f32 v236, v236, v150, v151
    s_waitcnt lgkmcnt(7)
    v_mfma_f32_32x32x16_bf16 v[152:167], v[168:171], v[8:11], 0
    s_waitcnt lgkmcnt(6)
    v_mfma_f32_32x32x16_bf16 v[152:167], v[172:175], v[12:15], v[152:167]
    s_waitcnt lgkmcnt(5)
    v_mfma_f32_32x32x16_bf16 v[152:167], v[176:179], v[16:19], v[152:167]
    s_waitcnt lgkmcnt(4)
    v_mfma_f32_32x32x16_bf16 v[152:167], v[180:183], v[20:23], v[152:167]
    s_waitcnt lgkmcnt(3)
    v_mfma_f32_32x32x16_bf16 v[152:167], v[184:187], v[24:27], v[152:167]
    s_waitcnt lgkmcnt(2)
    v_mfma_f32_32x32x16_bf16 v[152:167], v[188:191], v[28:31], v[152:167]
    s_waitcnt lgkmcnt(1)
    v_mfma_f32_32x32x16_bf16 v[152:167], v[192:195], v[32:35], v[152:167]
    s_waitcnt lgkmcnt(0)
    v_mfma_f32_32x32x16_bf16 v[152:167], v[196:199], v[36:39], v[152:167]
    s_waitcnt vmcnt(5)
    s_xor_b32 s40, s86, 49152
    buffer_load_dwordx4 v228, s[88:91], s40 offen offset:2048 nt lds
    s_add_u32 s50, s50, 1
    s_add_u32 s51, s51, 1
    s_add_u32 s60, s60, 1
    v_mov_b32 v237, 0
    v_mov_b32 v238, 0
    v_mov_b32 v239, 0
    v_mov_b32 v240, 0
    s_nop 4
    v_max3_f32 v236, v236, v152, v153
    v_max3_f32 v236, v236, v154, v155
    v_max3_f32 v236, v236, v156, v157
    v_max3_f32 v236, v236, v158, v159
    v_max3_f32 v236, v236, v160, v161
    v_max3_f32 v236, v236, v162, v163
    v_max3_f32 v236, v236, v164, v165
    v_max3_f32 v236, v236, v166, v167
    v_mov_b32 v244, v236
    v_cmp_eq_u32 vcc, 0, v0
    v_mov_b32 v32, s51
    v_permlane32_swap_b32 v236, v244
    v_mov_b32 v29, 0x7ffffff0
    v_mov_b32 v33, s41
    v_max_f32 v236, v236, v244
    v_mul_f32 v236, s46, v236
    ds_write_b32 v243, v236
    v_cndmask_b32 v29, v29, 0, vcc
    s_waitcnt vmcnt(5)
    buffer_load_dwordx4 v229, s[88:91], s40 offen offset:3072 nt lds
    s_waitcnt lgkmcnt(0)
    s_barrier
    ds_read_b128 v[244:247], v242
    buffer_store_dwordx2 v[32:33], v29, s[36:39], s54 offen offset:8 sc1
    v_lshlrev_b32 v26, 4, v241
    v_lshlrev_b32 v27, 4, v3
    v_add_u32 v30, 155648, v27
    v_cmp_gt_u32 vcc, 16, v0
    v_add_u32 v27, 2048, v27
    v_mov_b32 v31, 0x7ffffff0
    v_cndmask_b32 v31, v31, v27, vcc
    s_waitcnt lgkmcnt(0)
    v_max3_f32 v236, v244, v245, v246
    v_max_f32 v236, v236, v247
    s_waitcnt vmcnt(6)
    s_add_u32 m0, s45, 32768
    s_xor_b32 s40, s86, 65536
    buffer_load_dwordx4 v228, s[24:27], s40 offen offset:0 nt lds
    v_fma_f32 v40, v40, s46, -v236
    v_fma_f32 v41, v41, s46, -v236
    v_fma_f32 v42, v42, s46, -v236
    v_fma_f32 v43, v43, s46, -v236
    v_fma_f32 v44, v44, s46, -v236
    v_fma_f32 v45, v45, s46, -v236
    v_fma_f32 v46, v46, s46, -v236
    v_fma_f32 v47, v47, s46, -v236
    v_fma_f32 v48, v48, s46, -v236
    v_fma_f32 v49, v49, s46, -v236
    v_fma_f32 v50, v50, s46, -v236
    v_fma_f32 v51, v51, s46, -v236
    v_fma_f32 v52, v52, s46, -v236
    v_fma_f32 v53, v53, s46, -v236
    v_fma_f32 v54, v54, s46, -v236
    v_fma_f32 v55, v55, s46, -v236
    v_exp_f32 v40, v40
    v_exp_f32 v41, v41
    v_exp_f32 v42, v42
    v_exp_f32 v43, v43
    v_exp_f32 v44, v44
    v_exp_f32 v45, v45
    v_exp_f32 v46, v46
    v_exp_f32 v47, v47
    s_waitcnt vmcnt(6)
    buffer_load_dwordx4 v229, s[24:27], s40 offen offset:1024 nt lds
    v_exp_f32 v48, v48
    v_exp_f32 v49, v49
    v_exp_f32 v50, v50
    v_exp_f32 v51, v51
    v_exp_f32 v52, v52
    v_exp_f32 v53, v53
    v_exp_f32 v54, v54
    v_exp_f32 v55, v55
    v_add_f32 v237, v237, v40
    v_add_f32 v238, v238, v41
    v_add_f32 v239, v239, v42
    v_add_f32 v240, v240, v43
    v_add_f32 v237, v237, v44
    v_add_f32 v238, v238, v45
    v_add_f32 v239, v239, v46
    v_add_f32 v240, v240, v47
    v_add_f32 v237, v237, v48
    v_add_f32 v238, v238, v49
    v_add_f32 v239, v239, v50
    v_add_f32 v240, v240, v51
    v_add_f32 v237, v237, v52
    v_add_f32 v238, v238, v53
    v_add_f32 v239, v239, v54
    v_add_f32 v240, v240, v55
    v_cvt_pk_bf16_f32 v40, v40, v41
    v_cvt_pk_bf16_f32 v41, v42, v43
    v_cvt_pk_bf16_f32 v42, v44, v45
    v_cvt_pk_bf16_f32 v43, v46, v47
    v_cvt_pk_bf16_f32 v44, v48, v49
    v_cvt_pk_bf16_f32 v45, v50, v51
    v_cvt_pk_bf16_f32 v46, v52, v53
    v_cvt_pk_bf16_f32 v47, v54, v55
    ds_write_b128 v235, v[40:43] offset:0
    ds_write_b128 v235, v[44:47] offset:4096
    s_waitcnt vmcnt(6)
    s_xor_b32 s40, s86, 81920
    buffer_load_dwordx4 v228, s[88:91], s40 offen offset:2048 nt lds
    s_waitcnt vmcnt(6)
    buffer_load_dwordx4 v229, s[88:91], s40 offen offset:3072 nt lds
    v_bfe_u32 v4, v0, 4, 1
    v_lshl_add_u32 v4, v4, 4, v3
    v_lshlrev_b32 v4, 8, v4
    v_lshl_add_u32 v4, v5, 4, v4
    v_lshl_add_u32 v4, v1, 5, v4
    v_add_u32 v28, s49, v4
    s_waitcnt lgkmcnt(0)
    s_barrier
    ds_read_b128 v[168:171], v234 offset:0
    ds_read_b128 v[172:175], v234 offset:256
    ds_read_b128 v[176:179], v234 offset:1024
    ds_read_b128 v[180:183], v234 offset:1280
    ds_read_b128 v[184:187], v234 offset:2048
    ds_read_b128 v[188:191], v234 offset:2304
    ds_read_b128 v[192:195], v234 offset:3072
    ds_read_b128 v[196:199], v234 offset:3328
    ds_read_b64_tr_b16 v[200:201], v232 offset:0
    ds_read_b64_tr_b16 v[202:203], v232 offset:1024
    ds_read_b64_tr_b16 v[204:205], v232 offset:4096
    ds_read_b64_tr_b16 v[206:207], v232 offset:5120
    ds_read_b64_tr_b16 v[208:209], v232 offset:8192
    ds_read_b64_tr_b16 v[210:211], v232 offset:9216
    ds_read_b64_tr_b16 v[212:213], v232 offset:12288
    ds_read_b64_tr_b16 v[214:215], v232 offset:13312
    s_waitcnt vmcnt(6)
    s_add_u32 m0, s45, 49152
    s_xor_b32 s40, s86, 98304
    buffer_load_dwordx4 v228, s[24:27], s40 offen offset:0 nt lds
    v_fma_f32 v56, v56, s46, -v236
    v_fma_f32 v57, v57, s46, -v236
    v_fma_f32 v58, v58, s46, -v236
    v_fma_f32 v59, v59, s46, -v236
    v_fma_f32 v60, v60, s46, -v236
    v_fma_f32 v61, v61, s46, -v236
    v_fma_f32 v62, v62, s46, -v236
    v_fma_f32 v63, v63, s46, -v236
    v_fma_f32 v64, v64, s46, -v236
    v_fma_f32 v65, v65, s46, -v236
    v_fma_f32 v66, v66, s46, -v236
    v_fma_f32 v67, v67, s46, -v236
    v_fma_f32 v68, v68, s46, -v236
    v_fma_f32 v69, v69, s46, -v236
    v_fma_f32 v70, v70, s46, -v236
    v_fma_f32 v71, v71, s46, -v236
    v_exp_f32 v56, v56
    v_exp_f32 v57, v57
    v_exp_f32 v58, v58
    v_exp_f32 v59, v59
    v_exp_f32 v60, v60
    v_exp_f32 v61, v61
    v_exp_f32 v62, v62
    v_exp_f32 v63, v63
    s_waitcnt vmcnt(6)
    buffer_load_dwordx4 v229, s[24:27], s40 offen offset:1024 nt lds
    v_exp_f32 v64, v64
    v_exp_f32 v65, v65
    v_exp_f32 v66, v66
    v_exp_f32 v67, v67
    v_exp_f32 v68, v68
    v_exp_f32 v69, v69
    v_exp_f32 v70, v70
    v_exp_f32 v71, v71
    v_add_f32 v237, v237, v56
    v_add_f32 v238, v238, v57
    v_add_f32 v239, v239, v58
    v_add_f32 v240, v240, v59
    v_add_f32 v237, v237, v60
    v_add_f32 v238, v238, v61
    v_add_f32 v239, v239, v62
    v_add_f32 v240, v240, v63
    v_add_f32 v237, v237, v64
    v_add_f32 v238, v238, v65
    v_add_f32 v239, v239, v66
    v_add_f32 v240, v240, v67
    v_add_f32 v237, v237, v68
    v_add_f32 v238, v238, v69
    v_add_f32 v239, v239, v70
    v_add_f32 v240, v240, v71
    v_cvt_pk_bf16_f32 v56, v56, v57
    v_cvt_pk_bf16_f32 v57, v58, v59
    v_cvt_pk_bf16_f32 v58, v60, v61
    v_cvt_pk_bf16_f32 v59, v62, v63
    v_cvt_pk_bf16_f32 v60, v64, v65
    v_cvt_pk_bf16_f32 v61, v66, v67
    v_cvt_pk_bf16_f32 v62, v68, v69
    v_cvt_pk_bf16_f32 v63, v70, v71
    s_waitcnt lgkmcnt(6)
    v_mfma_f32_16x16x32_bf16 v[40:43], v[200:203], v[168:171], 0
    v_mfma_f32_16x16x32_bf16 v[44:47], v[200:203], v[172:175], 0
    s_waitcnt lgkmcnt(4)
    v_mfma_f32_16x16x32_bf16 v[40:43], v[204:207], v[176:179], v[40:43]
    v_mfma_f32_16x16x32_bf16 v[44:47], v[204:207], v[180:183], v[44:47]
    s_waitcnt lgkmcnt(2)
    v_mfma_f32_16x16x32_bf16 v[40:43], v[208:211], v[184:187], v[40:43]
    v_mfma_f32_16x16x32_bf16 v[44:47], v[208:211], v[188:191], v[44:47]
    s_waitcnt lgkmcnt(0)
    v_mfma_f32_16x16x32_bf16 v[40:43], v[212:215], v[192:195], v[40:43]
    v_mfma_f32_16x16x32_bf16 v[44:47], v[212:215], v[196:199], v[44:47]
    ds_write_b128 v235, v[56:59] offset:8192
    ds_write_b128 v235, v[60:63] offset:12288
    s_waitcnt vmcnt(5)
    s_xor_b32 s40, s86, 114688
    buffer_load_dwordx4 v228, s[88:91], s40 offen offset:2048 nt lds
    s_waitcnt lgkmcnt(0)
    s_barrier
    ds_read_b128 v[168:171], v234 offset:8192
    ds_read_b128 v[172:175], v234 offset:8448
    ds_read_b128 v[176:179], v234 offset:9216
    ds_read_b128 v[180:183], v234 offset:9472
    ds_read_b128 v[184:187], v234 offset:10240
    ds_read_b128 v[188:191], v234 offset:10496
    ds_read_b128 v[192:195], v234 offset:11264
    ds_read_b128 v[196:199], v234 offset:11520
    ds_read_b64_tr_b16 v[200:201], v232 offset:16384
    ds_read_b64_tr_b16 v[202:203], v232 offset:17408
    ds_read_b64_tr_b16 v[204:205], v232 offset:20480
    ds_read_b64_tr_b16 v[206:207], v232 offset:21504
    ds_read_b64_tr_b16 v[208:209], v232 offset:24576
    ds_read_b64_tr_b16 v[210:211], v232 offset:25600
    ds_read_b64_tr_b16 v[212:213], v232 offset:28672
    ds_read_b64_tr_b16 v[214:215], v232 offset:29696
    s_waitcnt vmcnt(5)
    buffer_load_dwordx4 v229, s[88:91], s40 offen offset:3072 nt lds
    v_fma_f32 v72, v72, s46, -v236
    v_fma_f32 v73, v73, s46, -v236
    v_fma_f32 v74, v74, s46, -v236
    v_fma_f32 v75, v75, s46, -v236
    v_fma_f32 v76, v76, s46, -v236
    v_fma_f32 v77, v77, s46, -v236
    v_fma_f32 v78, v78, s46, -v236
    v_fma_f32 v79, v79, s46, -v236
    v_fma_f32 v80, v80, s46, -v236
    v_fma_f32 v81, v81, s46, -v236
    v_fma_f32 v82, v82, s46, -v236
    v_fma_f32 v83, v83, s46, -v236
    v_fma_f32 v84, v84, s46, -v236
    v_fma_f32 v85, v85, s46, -v236
    v_fma_f32 v86, v86, s46, -v236
    v_fma_f32 v87, v87, s46, -v236
    v_exp_f32 v72, v72
    v_exp_f32 v73, v73
    v_exp_f32 v74, v74
    v_exp_f32 v75, v75
    v_exp_f32 v76, v76
    v_exp_f32 v77, v77
    v_exp_f32 v78, v78
    v_exp_f32 v79, v79
    s_waitcnt vmcnt(5)
    s_add_u32 m0, s45, 65536
    s_xor_b32 s40, s86, 131072
    buffer_load_dwordx4 v228, s[24:27], s40 offen offset:0 nt lds
    v_exp_f32 v80, v80
    v_exp_f32 v81, v81
    v_exp_f32 v82, v82
    v_exp_f32 v83, v83
    v_exp_f32 v84, v84
    v_exp_f32 v85, v85
    v_exp_f32 v86, v86
    v_exp_f32 v87, v87
    v_add_f32 v237, v237, v72
    v_add_f32 v238, v238, v73
    v_add_f32 v239, v239, v74
    v_add_f32 v240, v240, v75
    v_add_f32 v237, v237, v76
    v_add_f32 v238, v238, v77
    v_add_f32 v239, v239, v78
    v_add_f32 v240, v240, v79
    v_add_f32 v237, v237, v80
    v_add_f32 v238, v238, v81
    v_add_f32 v239, v239, v82
    v_add_f32 v240, v240, v83
    v_add_f32 v237, v237, v84
    v_add_f32 v238, v238, v85
    v_add_f32 v239, v239, v86
    v_add_f32 v240, v240, v87
    v_cvt_pk_bf16_f32 v72, v72, v73
    v_cvt_pk_bf16_f32 v73, v74, v75
    v_cvt_pk_bf16_f32 v74, v76, v77
    v_cvt_pk_bf16_f32 v75, v78, v79
    v_cvt_pk_bf16_f32 v76, v80, v81
    v_cvt_pk_bf16_f32 v77, v82, v83
    v_cvt_pk_bf16_f32 v78, v84, v85
    v_cvt_pk_bf16_f32 v79, v86, v87
    s_waitcnt lgkmcnt(6)
    v_mfma_f32_16x16x32_bf16 v[40:43], v[200:203], v[168:171], v[40:43]
    v_mfma_f32_16x16x32_bf16 v[44:47], v[200:203], v[172:175], v[44:47]
    s_waitcnt lgkmcnt(4)
    v_mfma_f32_16x16x32_bf16 v[40:43], v[204:207], v[176:179], v[40:43]
    v_mfma_f32_16x16x32_bf16 v[44:47], v[204:207], v[180:183], v[44:47]
    s_waitcnt lgkmcnt(2)
    v_mfma_f32_16x16x32_bf16 v[40:43], v[208:211], v[184:187], v[40:43]
    v_mfma_f32_16x16x32_bf16 v[44:47], v[208:211], v[188:191], v[44:47]
    s_waitcnt lgkmcnt(0)
    v_mfma_f32_16x16x32_bf16 v[40:43], v[212:215], v[192:195], v[40:43]
    v_mfma_f32_16x16x32_bf16 v[44:47], v[212:215], v[196:199], v[44:47]
    ds_write_b128 v235, v[72:75] offset:16384
    ds_write_b128 v235, v[76:79] offset:20480
    s_waitcnt vmcnt(5)
    buffer_load_dwordx4 v229, s[24:27], s40 offen offset:1024 nt lds
    s_waitcnt lgkmcnt(0)
    s_barrier
    ds_read_b128 v[168:171], v234 offset:16384
    ds_read_b128 v[172:175], v234 offset:16640
    ds_read_b128 v[176:179], v234 offset:17408
    ds_read_b128 v[180:183], v234 offset:17664
    ds_read_b128 v[184:187], v234 offset:18432
    ds_read_b128 v[188:191], v234 offset:18688
    ds_read_b128 v[192:195], v234 offset:19456
    ds_read_b128 v[196:199], v234 offset:19712
    ds_read_b64_tr_b16 v[200:201], v232 offset:32768
    ds_read_b64_tr_b16 v[202:203], v232 offset:33792
    ds_read_b64_tr_b16 v[204:205], v232 offset:36864
    ds_read_b64_tr_b16 v[206:207], v232 offset:37888
    ds_read_b64_tr_b16 v[208:209], v232 offset:40960
    ds_read_b64_tr_b16 v[210:211], v232 offset:41984
    ds_read_b64_tr_b16 v[212:213], v232 offset:45056
    ds_read_b64_tr_b16 v[214:215], v232 offset:46080
    s_waitcnt vmcnt(5)
    s_xor_b32 s40, s86, 147456
    buffer_load_dwordx4 v228, s[88:91], s40 offen offset:2048 nt lds
    v_fma_f32 v88, v88, s46, -v236
    v_fma_f32 v89, v89, s46, -v236
    v_fma_f32 v90, v90, s46, -v236
    v_fma_f32 v91, v91, s46, -v236
    v_fma_f32 v92, v92, s46, -v236
    v_fma_f32 v93, v93, s46, -v236
    v_fma_f32 v94, v94, s46, -v236
    v_fma_f32 v95, v95, s46, -v236
    v_fma_f32 v96, v96, s46, -v236
    v_fma_f32 v97, v97, s46, -v236
    v_fma_f32 v98, v98, s46, -v236
    v_fma_f32 v99, v99, s46, -v236
    v_fma_f32 v100, v100, s46, -v236
    v_fma_f32 v101, v101, s46, -v236
    v_fma_f32 v102, v102, s46, -v236
    v_fma_f32 v103, v103, s46, -v236
    v_exp_f32 v88, v88
    v_exp_f32 v89, v89
    v_exp_f32 v90, v90
    v_exp_f32 v91, v91
    v_exp_f32 v92, v92
    v_exp_f32 v93, v93
    v_exp_f32 v94, v94
    v_exp_f32 v95, v95
    s_waitcnt vmcnt(5)
    buffer_load_dwordx4 v229, s[88:91], s40 offen offset:3072 nt lds
    v_exp_f32 v96, v96
    v_exp_f32 v97, v97
    v_exp_f32 v98, v98
    v_exp_f32 v99, v99
    v_exp_f32 v100, v100
    v_exp_f32 v101, v101
    v_exp_f32 v102, v102
    v_exp_f32 v103, v103
    v_add_f32 v237, v237, v88
    v_add_f32 v238, v238, v89
    v_add_f32 v239, v239, v90
    v_add_f32 v240, v240, v91
    v_add_f32 v237, v237, v92
    v_add_f32 v238, v238, v93
    v_add_f32 v239, v239, v94
    v_add_f32 v240, v240, v95
    v_add_f32 v237, v237, v96
    v_add_f32 v238, v238, v97
    v_add_f32 v239, v239, v98
    v_add_f32 v240, v240, v99
    v_add_f32 v237, v237, v100
    v_add_f32 v238, v238, v101
    v_add_f32 v239, v239, v102
    v_add_f32 v240, v240, v103
    v_cvt_pk_bf16_f32 v88, v88, v89
    v_cvt_pk_bf16_f32 v89, v90, v91
    v_cvt_pk_bf16_f32 v90, v92, v93
    v_cvt_pk_bf16_f32 v91, v94, v95
    v_cvt_pk_bf16_f32 v92, v96, v97
    v_cvt_pk_bf16_f32 v93, v98, v99
    v_cvt_pk_bf16_f32 v94, v100, v101
    v_cvt_pk_bf16_f32 v95, v102, v103
    s_waitcnt lgkmcnt(6)
    v_mfma_f32_16x16x32_bf16 v[40:43], v[200:203], v[168:171], v[40:43]
    v_mfma_f32_16x16x32_bf16 v[44:47], v[200:203], v[172:175], v[44:47]
    s_waitcnt lgkmcnt(4)
    v_mfma_f32_16x16x32_bf16 v[40:43], v[204:207], v[176:179], v[40:43]
    v_mfma_f32_16x16x32_bf16 v[44:47], v[204:207], v[180:183], v[44:47]
    s_waitcnt lgkmcnt(2)
    v_mfma_f32_16x16x32_bf16 v[40:43], v[208:211], v[184:187], v[40:43]
    v_mfma_f32_16x16x32_bf16 v[44:47], v[208:211], v[188:191], v[44:47]
    s_waitcnt lgkmcnt(0)
    v_mfma_f32_16x16x32_bf16 v[40:43], v[212:215], v[192:195], v[40:43]
    v_mfma_f32_16x16x32_bf16 v[44:47], v[212:215], v[196:199], v[44:47]
    ds_write_b128 v235, v[88:91] offset:24576
    ds_write_b128 v235, v[92:95] offset:28672
    s_waitcnt vmcnt(5)
    s_add_u32 m0, s45, 0
    s_xor_b32 s40, s86, 163840
    buffer_load_dwordx4 v228, s[24:27], s40 offen offset:0 nt lds
    s_waitcnt vmcnt(5)
    buffer_load_dwordx4 v229, s[24:27], s40 offen offset:1024 nt lds
    s_waitcnt lgkmcnt(0)
    s_barrier
    ds_read_b128 v[168:171], v234 offset:24576
    ds_read_b128 v[172:175], v234 offset:24832
    ds_read_b128 v[176:179], v234 offset:25600
    ds_read_b128 v[180:183], v234 offset:25856
    ds_read_b128 v[184:187], v234 offset:26624
    ds_read_b128 v[188:191], v234 offset:26880
    ds_read_b128 v[192:195], v234 offset:27648
    ds_read_b128 v[196:199], v234 offset:27904
    ds_read_b64_tr_b16 v[200:201], v232 offset:49152
    ds_read_b64_tr_b16 v[202:203], v232 offset:50176
    ds_read_b64_tr_b16 v[204:205], v232 offset:53248
    ds_read_b64_tr_b16 v[206:207], v232 offset:54272
    ds_read_b64_tr_b16 v[208:209], v232 offset:57344
    ds_read_b64_tr_b16 v[210:211], v232 offset:58368
    ds_read_b64_tr_b16 v[212:213], v232 offset:61440
    ds_read_b64_tr_b16 v[214:215], v232 offset:62464
    s_waitcnt vmcnt(5)
    s_xor_b32 s40, s86, 180224
    buffer_load_dwordx4 v228, s[88:91], s40 offen offset:2048 nt lds
    v_fma_f32 v104, v104, s46, -v236
    v_fma_f32 v105, v105, s46, -v236
    v_fma_f32 v106, v106, s46, -v236
    v_fma_f32 v107, v107, s46, -v236
    v_fma_f32 v108, v108, s46, -v236
    v_fma_f32 v109, v109, s46, -v236
    v_fma_f32 v110, v110, s46, -v236
    v_fma_f32 v111, v111, s46, -v236
    v_fma_f32 v112, v112, s46, -v236
    v_fma_f32 v113, v113, s46, -v236
    v_fma_f32 v114, v114, s46, -v236
    v_fma_f32 v115, v115, s46, -v236
    v_fma_f32 v116, v116, s46, -v236
    v_fma_f32 v117, v117, s46, -v236
    v_fma_f32 v118, v118, s46, -v236
    v_fma_f32 v119, v119, s46, -v236
    v_exp_f32 v104, v104
    v_exp_f32 v105, v105
    v_exp_f32 v106, v106
    v_exp_f32 v107, v107
    v_exp_f32 v108, v108
    v_exp_f32 v109, v109
    v_exp_f32 v110, v110
    v_exp_f32 v111, v111
    s_waitcnt vmcnt(5)
    buffer_load_dwordx4 v229, s[88:91], s40 offen offset:3072 nt lds
    v_exp_f32 v112, v112
    v_exp_f32 v113, v113
    v_exp_f32 v114, v114
    v_exp_f32 v115, v115
    v_exp_f32 v116, v116
    v_exp_f32 v117, v117
    v_exp_f32 v118, v118
    v_exp_f32 v119, v119
    v_add_f32 v237, v237, v104
    v_add_f32 v238, v238, v105
    v_add_f32 v239, v239, v106
    v_add_f32 v240, v240, v107
    v_add_f32 v237, v237, v108
    v_add_f32 v238, v238, v109
    v_add_f32 v239, v239, v110
    v_add_f32 v240, v240, v111
    v_add_f32 v237, v237, v112
    v_add_f32 v238, v238, v113
    v_add_f32 v239, v239, v114
    v_add_f32 v240, v240, v115
    v_add_f32 v237, v237, v116
    v_add_f32 v238, v238, v117
    v_add_f32 v239, v239, v118
    v_add_f32 v240, v240, v119
    v_cvt_pk_bf16_f32 v104, v104, v105
    v_cvt_pk_bf16_f32 v105, v106, v107
    v_cvt_pk_bf16_f32 v106, v108, v109
    v_cvt_pk_bf16_f32 v107, v110, v111
    v_cvt_pk_bf16_f32 v108, v112, v113
    v_cvt_pk_bf16_f32 v109, v114, v115
    v_cvt_pk_bf16_f32 v110, v116, v117
    v_cvt_pk_bf16_f32 v111, v118, v119
    s_waitcnt lgkmcnt(6)
    v_mfma_f32_16x16x32_bf16 v[40:43], v[200:203], v[168:171], v[40:43]
    v_mfma_f32_16x16x32_bf16 v[44:47], v[200:203], v[172:175], v[44:47]
    s_waitcnt lgkmcnt(4)
    v_mfma_f32_16x16x32_bf16 v[40:43], v[204:207], v[176:179], v[40:43]
    v_mfma_f32_16x16x32_bf16 v[44:47], v[204:207], v[180:183], v[44:47]
    s_waitcnt lgkmcnt(2)
    v_mfma_f32_16x16x32_bf16 v[40:43], v[208:211], v[184:187], v[40:43]
    v_mfma_f32_16x16x32_bf16 v[44:47], v[208:211], v[188:191], v[44:47]
    s_waitcnt lgkmcnt(0)
    v_mfma_f32_16x16x32_bf16 v[40:43], v[212:215], v[192:195], v[40:43]
    v_mfma_f32_16x16x32_bf16 v[44:47], v[212:215], v[196:199], v[44:47]
    ds_write_b128 v235, v[104:107] offset:32768
    ds_write_b128 v235, v[108:111] offset:36864
    s_waitcnt vmcnt(5)
    s_add_u32 m0, s45, 16384
    s_xor_b32 s40, s86, 196608
    buffer_load_dwordx4 v228, s[24:27], s40 offen offset:0 nt lds
    s_waitcnt vmcnt(5)
    buffer_load_dwordx4 v229, s[24:27], s40 offen offset:1024 nt lds
    s_waitcnt lgkmcnt(0)
    s_barrier
    ds_read_b128 v[168:171], v234 offset:32768
    ds_read_b128 v[172:175], v234 offset:33024
    ds_read_b128 v[176:179], v234 offset:33792
    ds_read_b128 v[180:183], v234 offset:34048
    ds_read_b128 v[184:187], v234 offset:34816
    ds_read_b128 v[188:191], v234 offset:35072
    ds_read_b128 v[192:195], v234 offset:35840
    ds_read_b128 v[196:199], v234 offset:36096
    ds_read_b64_tr_b16 v[200:201], v233 offset:0
    ds_read_b64_tr_b16 v[202:203], v233 offset:1024
    ds_read_b64_tr_b16 v[204:205], v233 offset:4096
    ds_read_b64_tr_b16 v[206:207], v233 offset:5120
    ds_read_b64_tr_b16 v[208:209], v233 offset:8192
    ds_read_b64_tr_b16 v[210:211], v233 offset:9216
    ds_read_b64_tr_b16 v[212:213], v233 offset:12288
    ds_read_b64_tr_b16 v[214:215], v233 offset:13312
    s_waitcnt vmcnt(5)
    s_xor_b32 s40, s86, 212992
    buffer_load_dwordx4 v228, s[88:91], s40 offen offset:2048 nt lds
    v_fma_f32 v120, v120, s46, -v236
    v_fma_f32 v121, v121, s46, -v236
    v_fma_f32 v122, v122, s46, -v236
    v_fma_f32 v123, v123, s46, -v236
    v_fma_f32 v124, v124, s46, -v236
    v_fma_f32 v125, v125, s46, -v236
    v_fma_f32 v126, v126, s46, -v236
    v_fma_f32 v127, v127, s46, -v236
    v_fma_f32 v128, v128, s46, -v236
    v_fma_f32 v129, v129, s46, -v236
    v_fma_f32 v130, v130, s46, -v236
    v_fma_f32 v131, v131, s46, -v236
    v_fma_f32 v132, v132, s46, -v236
    v_fma_f32 v133, v133, s46, -v236
    v_fma_f32 v134, v134, s46, -v236
    v_fma_f32 v135, v135, s46, -v236
    v_exp_f32 v120, v120
    v_exp_f32 v121, v121
    v_exp_f32 v122, v122
    v_exp_f32 v123, v123
    v_exp_f32 v124, v124
    v_exp_f32 v125, v125
    v_exp_f32 v126, v126
    v_exp_f32 v127, v127
    s_waitcnt vmcnt(5)
    buffer_load_dwordx4 v229, s[88:91], s40 offen offset:3072 nt lds
    v_exp_f32 v128, v128
    v_exp_f32 v129, v129
    v_exp_f32 v130, v130
    v_exp_f32 v131, v131
    v_exp_f32 v132, v132
    v_exp_f32 v133, v133
    v_exp_f32 v134, v134
    v_exp_f32 v135, v135
    v_add_f32 v237, v237, v120
    v_add_f32 v238, v238, v121
    v_add_f32 v239, v239, v122
    v_add_f32 v240, v240, v123
    v_add_f32 v237, v237, v124
    v_add_f32 v238, v238, v125
    v_add_f32 v239, v239, v126
    v_add_f32 v240, v240, v127
    v_add_f32 v237, v237, v128
    v_add_f32 v238, v238, v129
    v_add_f32 v239, v239, v130
    v_add_f32 v240, v240, v131
    v_add_f32 v237, v237, v132
    v_add_f32 v238, v238, v133
    v_add_f32 v239, v239, v134
    v_add_f32 v240, v240, v135
    v_cvt_pk_bf16_f32 v120, v120, v121
    v_cvt_pk_bf16_f32 v121, v122, v123
    v_cvt_pk_bf16_f32 v122, v124, v125
    v_cvt_pk_bf16_f32 v123, v126, v127
    v_cvt_pk_bf16_f32 v124, v128, v129
    v_cvt_pk_bf16_f32 v125, v130, v131
    v_cvt_pk_bf16_f32 v126, v132, v133
    v_cvt_pk_bf16_f32 v127, v134, v135
    s_waitcnt lgkmcnt(6)
    v_mfma_f32_16x16x32_bf16 v[40:43], v[200:203], v[168:171], v[40:43]
    v_mfma_f32_16x16x32_bf16 v[44:47], v[200:203], v[172:175], v[44:47]
    s_waitcnt lgkmcnt(4)
    v_mfma_f32_16x16x32_bf16 v[40:43], v[204:207], v[176:179], v[40:43]
    v_mfma_f32_16x16x32_bf16 v[44:47], v[204:207], v[180:183], v[44:47]
    s_waitcnt lgkmcnt(2)
    v_mfma_f32_16x16x32_bf16 v[40:43], v[208:211], v[184:187], v[40:43]
    v_mfma_f32_16x16x32_bf16 v[44:47], v[208:211], v[188:191], v[44:47]
    s_waitcnt lgkmcnt(0)
    v_mfma_f32_16x16x32_bf16 v[40:43], v[212:215], v[192:195], v[40:43]
    v_mfma_f32_16x16x32_bf16 v[44:47], v[212:215], v[196:199], v[44:47]
    ds_write_b128 v235, v[120:123] offset:40960
    ds_write_b128 v235, v[124:127] offset:45056
    s_waitcnt vmcnt(5)
    s_add_u32 m0, s45, 32768
    s_xor_b32 s40, s86, 229376
    buffer_load_dwordx4 v228, s[24:27], s40 offen offset:0 nt lds
    s_waitcnt vmcnt(5)
    buffer_load_dwordx4 v229, s[24:27], s40 offen offset:1024 nt lds
    s_waitcnt lgkmcnt(0)
    s_barrier
    ds_read_b128 v[168:171], v234 offset:40960
    ds_read_b128 v[172:175], v234 offset:41216
    ds_read_b128 v[176:179], v234 offset:41984
    ds_read_b128 v[180:183], v234 offset:42240
    ds_read_b128 v[184:187], v234 offset:43008
    ds_read_b128 v[188:191], v234 offset:43264
    ds_read_b128 v[192:195], v234 offset:44032
    ds_read_b128 v[196:199], v234 offset:44288
    ds_read_b64_tr_b16 v[200:201], v232 offset:0
    ds_read_b64_tr_b16 v[202:203], v232 offset:1024
    ds_read_b64_tr_b16 v[204:205], v232 offset:4096
    ds_read_b64_tr_b16 v[206:207], v232 offset:5120
    ds_read_b64_tr_b16 v[208:209], v232 offset:8192
    ds_read_b64_tr_b16 v[210:211], v232 offset:9216
    ds_read_b64_tr_b16 v[212:213], v232 offset:12288
    ds_read_b64_tr_b16 v[214:215], v232 offset:13312
    buffer_load_dwordx2 v[34:35], off, s[36:39], s55 offset:8 sc1
    s_waitcnt vmcnt(6)
    s_xor_b32 s40, s86, 245760
    buffer_load_dwordx4 v228, s[88:91], s40 offen offset:2048 nt lds
    v_fma_f32 v136, v136, s46, -v236
    v_fma_f32 v137, v137, s46, -v236
    v_fma_f32 v138, v138, s46, -v236
    v_fma_f32 v139, v139, s46, -v236
    v_fma_f32 v140, v140, s46, -v236
    v_fma_f32 v141, v141, s46, -v236
    v_fma_f32 v142, v142, s46, -v236
    v_fma_f32 v143, v143, s46, -v236
    v_fma_f32 v144, v144, s46, -v236
    v_fma_f32 v145, v145, s46, -v236
    v_fma_f32 v146, v146, s46, -v236
    v_fma_f32 v147, v147, s46, -v236
    v_fma_f32 v148, v148, s46, -v236
    v_fma_f32 v149, v149, s46, -v236
    v_fma_f32 v150, v150, s46, -v236
    v_fma_f32 v151, v151, s46, -v236
    v_exp_f32 v136, v136
    v_exp_f32 v137, v137
    v_exp_f32 v138, v138
    v_exp_f32 v139, v139
    v_exp_f32 v140, v140
    v_exp_f32 v141, v141
    v_exp_f32 v142, v142
    v_exp_f32 v143, v143
    s_waitcnt vmcnt(6)
    buffer_load_dwordx4 v229, s[88:91], s40 offen offset:3072 nt lds
    v_exp_f32 v144, v144
    v_exp_f32 v145, v145
    v_exp_f32 v146, v146
    v_exp_f32 v147, v147
    v_exp_f32 v148, v148
    v_exp_f32 v149, v149
    v_exp_f32 v150, v150
    v_exp_f32 v151, v151
    v_add_f32 v237, v237, v136
    v_add_f32 v238, v238, v137
    v_add_f32 v239, v239, v138
    v_add_f32 v240, v240, v139
    v_add_f32 v237, v237, v140
    v_add_f32 v238, v238, v141
    v_add_f32 v239, v239, v142
    v_add_f32 v240, v240, v143
    v_add_f32 v237, v237, v144
    v_add_f32 v238, v238, v145
    v_add_f32 v239, v239, v146
    v_add_f32 v240, v240, v147
    v_add_f32 v237, v237, v148
    v_add_f32 v238, v238, v149
    v_add_f32 v239, v239, v150
    v_add_f32 v240, v240, v151
    v_cvt_pk_bf16_f32 v136, v136, v137
    v_cvt_pk_bf16_f32 v137, v138, v139
    v_cvt_pk_bf16_f32 v138, v140, v141
    v_cvt_pk_bf16_f32 v139, v142, v143
    v_cvt_pk_bf16_f32 v140, v144, v145
    v_cvt_pk_bf16_f32 v141, v146, v147
    v_cvt_pk_bf16_f32 v142, v148, v149
    v_cvt_pk_bf16_f32 v143, v150, v151
    s_waitcnt lgkmcnt(6)
    v_mfma_f32_16x16x32_bf16 v[40:43], v[200:203], v[168:171], v[40:43]
    v_mfma_f32_16x16x32_bf16 v[44:47], v[200:203], v[172:175], v[44:47]
    s_waitcnt lgkmcnt(4)
    v_mfma_f32_16x16x32_bf16 v[40:43], v[204:207], v[176:179], v[40:43]
    v_mfma_f32_16x16x32_bf16 v[44:47], v[204:207], v[180:183], v[44:47]
    s_waitcnt lgkmcnt(2)
    v_mfma_f32_16x16x32_bf16 v[40:43], v[208:211], v[184:187], v[40:43]
    v_mfma_f32_16x16x32_bf16 v[44:47], v[208:211], v[188:191], v[44:47]
    s_waitcnt lgkmcnt(0)
    v_mfma_f32_16x16x32_bf16 v[40:43], v[212:215], v[192:195], v[40:43]
    v_mfma_f32_16x16x32_bf16 v[44:47], v[212:215], v[196:199], v[44:47]
    ds_write_b128 v235, v[136:139] offset:49152
    ds_write_b128 v235, v[140:143] offset:53248
    s_waitcnt vmcnt(6)
    s_add_u32 m0, s45, 49152
    s_xor_b32 s40, s86, 0
    buffer_load_dwordx4 v230, s[24:27], s40 offen offset:0 nt lds
    s_waitcnt vmcnt(6)
    buffer_load_dwordx4 v231, s[24:27], s40 offen offset:1024 nt lds
    s_waitcnt lgkmcnt(0)
    s_barrier
    ds_read_b128 v[168:171], v234 offset:49152
    ds_read_b128 v[172:175], v234 offset:49408
    ds_read_b128 v[176:179], v234 offset:50176
    ds_read_b128 v[180:183], v234 offset:50432
    ds_read_b128 v[184:187], v234 offset:51200
    ds_read_b128 v[188:191], v234 offset:51456
    ds_read_b128 v[192:195], v234 offset:52224
    ds_read_b128 v[196:199], v234 offset:52480
    ds_read_b64_tr_b16 v[200:201], v232 offset:16384
    ds_read_b64_tr_b16 v[202:203], v232 offset:17408
    ds_read_b64_tr_b16 v[204:205], v232 offset:20480
    ds_read_b64_tr_b16 v[206:207], v232 offset:21504
    ds_read_b64_tr_b16 v[208:209], v232 offset:24576
    ds_read_b64_tr_b16 v[210:211], v232 offset:25600
    ds_read_b64_tr_b16 v[212:213], v232 offset:28672
    ds_read_b64_tr_b16 v[214:215], v232 offset:29696
    s_waitcnt vmcnt(6)
    s_xor_b32 s40, s86, 16384
    buffer_load_dwordx4 v230, s[88:91], s40 offen offset:2048 nt lds
    v_fma_f32 v152, v152, s46, -v236
    v_fma_f32 v153, v153, s46, -v236
    v_fma_f32 v154, v154, s46, -v236
    v_fma_f32 v155, v155, s46, -v236
    v_fma_f32 v156, v156, s46, -v236
    v_fma_f32 v157, v157, s46, -v236
    v_fma_f32 v158, v158, s46, -v236
    v_fma_f32 v159, v159, s46, -v236
    v_fma_f32 v160, v160, s46, -v236
    v_fma_f32 v161, v161, s46, -v236
    v_fma_f32 v162, v162, s46, -v236
    v_fma_f32 v163, v163, s46, -v236
    v_fma_f32 v164, v164, s46, -v236
    v_fma_f32 v165, v165, s46, -v236
    v_fma_f32 v166, v166, s46, -v236
    v_fma_f32 v167, v167, s46, -v236
    v_exp_f32 v152, v152
    v_exp_f32 v153, v153
    v_exp_f32 v154, v154
    v_exp_f32 v155, v155
    v_exp_f32 v156, v156
    v_exp_f32 v157, v157
    v_exp_f32 v158, v158
    v_exp_f32 v159, v159
    s_waitcnt vmcnt(6)
    buffer_load_dwordx4 v231, s[88:91], s40 offen offset:3072 nt lds
    v_exp_f32 v160, v160
    v_exp_f32 v161, v161
    v_exp_f32 v162, v162
    v_exp_f32 v163, v163
    v_exp_f32 v164, v164
    v_exp_f32 v165, v165
    v_exp_f32 v166, v166
    v_exp_f32 v167, v167
    v_add_f32 v237, v237, v152
    v_add_f32 v238, v238, v153
    v_add_f32 v239, v239, v154
    v_add_f32 v240, v240, v155
    v_add_f32 v237, v237, v156
    v_add_f32 v238, v238, v157
    v_add_f32 v239, v239, v158
    v_add_f32 v240, v240, v159
    v_add_f32 v237, v237, v160
    v_add_f32 v238, v238, v161
    v_add_f32 v239, v239, v162
    v_add_f32 v240, v240, v163
    v_add_f32 v237, v237, v164
    v_add_f32 v238, v238, v165
    v_add_f32 v239, v239, v166
    v_add_f32 v240, v240, v167
    v_cvt_pk_bf16_f32 v152, v152, v153
    v_cvt_pk_bf16_f32 v153, v154, v155
    v_cvt_pk_bf16_f32 v154, v156, v157
    v_cvt_pk_bf16_f32 v155, v158, v159
    v_cvt_pk_bf16_f32 v156, v160, v161
    v_cvt_pk_bf16_f32 v157, v162, v163
    v_cvt_pk_bf16_f32 v158, v164, v165
    v_cvt_pk_bf16_f32 v159, v166, v167
    v_add_f32 v237, v237, v238
    v_add_f32 v239, v239, v240
    v_add_f32 v237, v237, v239
    v_mov_b32 v238, v237
    s_nop 1
    v_permlane32_swap_b32 v237, v238
    s_nop 0
    v_add_f32 v237, v237, v238
    s_waitcnt lgkmcnt(6)
    v_mfma_f32_16x16x32_bf16 v[40:43], v[200:203], v[168:171], v[40:43]
    v_mfma_f32_16x16x32_bf16 v[44:47], v[200:203], v[172:175], v[44:47]
    s_waitcnt lgkmcnt(4)
    v_mfma_f32_16x16x32_bf16 v[40:43], v[204:207], v[176:179], v[40:43]
    v_mfma_f32_16x16x32_bf16 v[44:47], v[204:207], v[180:183], v[44:47]
    s_waitcnt lgkmcnt(2)
    v_mfma_f32_16x16x32_bf16 v[40:43], v[208:211], v[184:187], v[40:43]
    v_mfma_f32_16x16x32_bf16 v[44:47], v[208:211], v[188:191], v[44:47]
    s_waitcnt lgkmcnt(0)
    v_mfma_f32_16x16x32_bf16 v[40:43], v[212:215], v[192:195], v[40:43]
    v_mfma_f32_16x16x32_bf16 v[44:47], v[212:215], v[196:199], v[44:47]
    ds_write_b128 v235, v[152:155] offset:57344
    ds_write_b128 v235, v[156:159] offset:61440
    ds_write_b32 v243, v237 offset:512
    s_waitcnt vmcnt(5)
    s_add_u32 m0, s45, 65536
    s_xor_b32 s40, s86, 32768
    buffer_load_dwordx4 v230, s[24:27], s40 offen offset:0 nt lds
    s_waitcnt vmcnt(5)
    buffer_load_dwordx4 v231, s[24:27], s40 offen offset:1024 nt lds
    s_waitcnt lgkmcnt(0)
    s_barrier
    ds_read_b128 v[168:171], v234 offset:57344
    ds_read_b128 v[172:175], v234 offset:57600
    ds_read_b128 v[176:179], v234 offset:58368
    ds_read_b128 v[180:183], v234 offset:58624
    ds_read_b128 v[184:187], v234 offset:59392
    ds_read_b128 v[188:191], v234 offset:59648
    ds_read_b128 v[192:195], v234 offset:60416
    ds_read_b128 v[196:199], v234 offset:60672
    ds_read_b64_tr_b16 v[200:201], v232 offset:32768
    ds_read_b64_tr_b16 v[202:203], v232 offset:33792
    ds_read_b64_tr_b16 v[204:205], v232 offset:36864
    ds_read_b64_tr_b16 v[206:207], v232 offset:37888
    ds_read_b64_tr_b16 v[208:209], v232 offset:40960
    ds_read_b64_tr_b16 v[210:211], v232 offset:41984
    ds_read_b64_tr_b16 v[212:213], v232 offset:45056
    ds_read_b64_tr_b16 v[214:215], v232 offset:46080
    s_waitcnt vmcnt(5)
    s_xor_b32 s40, s86, 49152
    buffer_load_dwordx4 v230, s[88:91], s40 offen offset:2048 nt lds
    s_waitcnt lgkmcnt(6)
    v_mfma_f32_16x16x32_bf16 v[40:43], v[200:203], v[168:171], v[40:43]
    v_mfma_f32_16x16x32_bf16 v[44:47], v[200:203], v[172:175], v[44:47]
    s_waitcnt lgkmcnt(4)
    v_mfma_f32_16x16x32_bf16 v[40:43], v[204:207], v[176:179], v[40:43]
    v_mfma_f32_16x16x32_bf16 v[44:47], v[204:207], v[180:183], v[44:47]
    s_waitcnt lgkmcnt(2)
    v_mfma_f32_16x16x32_bf16 v[40:43], v[208:211], v[184:187], v[40:43]
    v_mfma_f32_16x16x32_bf16 v[44:47], v[208:211], v[188:191], v[44:47]
    s_waitcnt lgkmcnt(0)
    v_mfma_f32_16x16x32_bf16 v[40:43], v[212:215], v[192:195], v[40:43]
    v_mfma_f32_16x16x32_bf16 v[44:47], v[212:215], v[196:199], v[44:47]
    ds_read_b128 v[56:59], v30 offset:0
    ds_read_b128 v[60:63], v30 offset:256
    ds_read_b128 v[64:67], v30 offset:512
    ds_read_b128 v[68:71], v30 offset:768
    ds_read_b128 v[168:171], v234 offset:0
    ds_read_b128 v[172:175], v234 offset:256
    ds_read_b128 v[176:179], v234 offset:1024
    ds_read_b128 v[180:183], v234 offset:1280
    ds_read_b128 v[184:187], v234 offset:2048
    ds_read_b128 v[188:191], v234 offset:2304
    ds_read_b128 v[192:195], v234 offset:3072
    ds_read_b128 v[196:199], v234 offset:3328
    s_waitcnt lgkmcnt(8)
    v_max3_f32 v8, v56, v57, v58
    v_max3_f32 v10, v60, v61, v62
    v_add_f32 v9, v64, v65
    v_add_f32 v11, v68, v69
    v_max_f32 v8, v8, v59
    v_max_f32 v10, v10, v63
    v_add_f32 v66, v66, v67
    v_add_f32 v70, v70, v71
    v_add_f32 v9, v9, v66
    v_add_f32 v11, v11, v70
    v_readfirstlane_b32 s42, v34
    v_readfirstlane_b32 s47, v35
    v_cvt_pk_bf16_f32 v40, v40, v41
    v_cvt_pk_bf16_f32 v41, v42, v43
    v_cvt_pk_bf16_f32 v42, v44, v45
    v_cvt_pk_bf16_f32 v43, v46, v47
    s_cmp_lg_u32 s42, s63
    s_cselect_b32 s42, 1, 0
    s_cmp_eq_u32 s47, s41
    s_cselect_b32 s47, s42, 0
    s_cmp_eq_u32 s47, 0
    s_cbranch_scc1 L_pubfar
    buffer_store_dwordx4 v[40:43], v26, s[36:39], s58 offen
    buffer_store_dwordx4 v[8:11], v31, s[36:39], s43 offen
L_pubback:
    s_waitcnt vmcnt(7)
    buffer_load_dwordx4 v231, s[88:91], s40 offen offset:3072 nt lds
    s_waitcnt vmcnt(7)
    s_add_u32 m0, s45, 0
    s_xor_b32 s40, s86, 65536
    buffer_load_dwordx4 v230, s[24:27], s40 offen offset:0 nt lds
    s_waitcnt vmcnt(7)
    buffer_load_dwordx4 v231, s[24:27], s40 offen offset:1024 nt lds
    s_barrier
    ds_read_b64_tr_b16 v[200:201], v232 offset:49152
    ds_read_b64_tr_b16 v[202:203], v232 offset:50176
    ds_read_b64_tr_b16 v[204:205], v232 offset:53248
    ds_read_b64_tr_b16 v[206:207], v232 offset:54272
    ds_read_b64_tr_b16 v[208:209], v232 offset:57344
    ds_read_b64_tr_b16 v[210:211], v232 offset:58368
    ds_read_b64_tr_b16 v[212:213], v232 offset:61440
    ds_read_b64_tr_b16 v[214:215], v232 offset:62464
    s_waitcnt vmcnt(7)
    s_xor_b32 s40, s86, 81920
    buffer_load_dwordx4 v230, s[88:91], s40 offen offset:2048 nt lds
    s_waitcnt lgkmcnt(6)
    v_mfma_f32_16x16x32_bf16 v[48:51], v[200:203], v[168:171], 0
    v_mfma_f32_16x16x32_bf16 v[52:55], v[200:203], v[172:175], 0
    s_waitcnt lgkmcnt(4)
    v_mfma_f32_16x16x32_bf16 v[48:51], v[204:207], v[176:179], v[48:51]
    v_mfma_f32_16x16x32_bf16 v[52:55], v[204:207], v[180:183], v[52:55]
    s_waitcnt lgkmcnt(2)
    v_mfma_f32_16x16x32_bf16 v[48:51], v[208:211], v[184:187], v[48:51]
    v_mfma_f32_16x16x32_bf16 v[52:55], v[208:211], v[188:191], v[52:55]
    s_waitcnt lgkmcnt(0)
    v_mfma_f32_16x16x32_bf16 v[48:51], v[212:215], v[192:195], v[48:51]
    v_mfma_f32_16x16x32_bf16 v[52:55], v[212:215], v[196:199], v[52:55]
    ds_read_b128 v[168:171], v234 offset:8192
    ds_read_b128 v[172:175], v234 offset:8448
    ds_read_b128 v[176:179], v234 offset:9216
    ds_read_b128 v[180:183], v234 offset:9472
    ds_read_b128 v[184:187], v234 offset:10240
    ds_read_b128 v[188:191], v234 offset:10496
    ds_read_b128 v[192:195], v234 offset:11264
    ds_read_b128 v[196:199], v234 offset:11520
    s_waitcnt vmcnt(7)
    buffer_load_dwordx4 v231, s[88:91], s40 offen offset:3072 nt lds
    s_waitcnt vmcnt(7)
    s_add_u32 m0, s45, 16384
    s_xor_b32 s40, s86, 98304
    buffer_load_dwordx4 v230, s[24:27], s40 offen offset:0 nt lds
    s_waitcnt vmcnt(5)
    buffer_load_dwordx4 v231, s[24:27], s40 offen offset:1024 nt lds
    s_barrier
    ds_read_b64_tr_b16 v[200:201], v233 offset:0
    ds_read_b64_tr_b16 v[202:203], v233 offset:1024
    ds_read_b64_tr_b16 v[204:205], v233 offset:4096
    ds_read_b64_tr_b16 v[206:207], v233 offset:5120
    ds_read_b64_tr_b16 v[208:209], v233 offset:8192
    ds_read_b64_tr_b16 v[210:211], v233 offset:9216
    ds_read_b64_tr_b16 v[212:213], v233 offset:12288
    ds_read_b64_tr_b16 v[214:215], v233 offset:13312
    v_mov_b32 v32, s50
    s_cmp_eq_u32 s47, 0
    s_cbranch_scc1 L_flagfar
    buffer_store_dword v32, v29, s[36:39], s54 offen
L_dbgback:
    s_waitcnt vmcnt(6)
    s_xor_b32 s40, s86, 114688
    buffer_load_dwordx4 v230, s[88:91], s40 offen offset:2048 nt lds
    s_waitcnt lgkmcnt(6)
    v_mfma_f32_16x16x32_bf16 v[48:51], v[200:203], v[168:171], v[48:51]
    v_mfma_f32_16x16x32_bf16 v[52:55], v[200:203], v[172:175], v[52:55]
    s_waitcnt lgkmcnt(4)
    v_mfma_f32_16x16x32_bf16 v[48:51], v[204:207], v[176:179], v[48:51]
    v_mfma_f32_16x16x32_bf16 v[52:55], v[204:207], v[180:183], v[52:55]
    s_waitcnt lgkmcnt(2)
    v_mfma_f32_16x16x32_bf16 v[48:51], v[208:211], v[184:187], v[48:51]
    v_mfma_f32_16x16x32_bf16 v[52:55], v[208:211], v[188:191], v[52:55]
    s_waitcnt lgkmcnt(0)
    v_mfma_f32_16x16x32_bf16 v[48:51], v[212:215], v[192:195], v[48:51]
    v_mfma_f32_16x16x32_bf16 v[52:55], v[212:215], v[196:199], v[52:55]
    ds_read_b128 v[168:171], v234 offset:16384
    ds_read_b128 v[172:175], v234 offset:16640
    ds_read_b128 v[176:179], v234 offset:17408
    ds_read_b128 v[180:183], v234 offset:17664
    ds_read_b128 v[184:187], v234 offset:18432
    ds_read_b128 v[188:191], v234 offset:18688
    ds_read_b128 v[192:195], v234 offset:19456
    ds_read_b128 v[196:199], v234 offset:19712
    s_waitcnt vmcnt(6)
    buffer_load_dwordx4 v231, s[88:91], s40 offen offset:3072 nt lds
    s_waitcnt vmcnt(6)
    s_add_u32 m0, s45, 32768
    s_xor_b32 s40, s86, 131072
    buffer_load_dwordx4 v230, s[24:27], s40 offen offset:0 nt lds
    s_waitcnt vmcnt(6)
    buffer_load_dwordx4 v231, s[24:27], s40 offen offset:1024 nt lds
    s_barrier
    ds_read_b64_tr_b16 v[200:201], v232 offset:0
    ds_read_b64_tr_b16 v[202:203], v232 offset:1024
    ds_read_b64_tr_b16 v[204:205], v232 offset:4096
    ds_read_b64_tr_b16 v[206:207], v232 offset:5120
    ds_read_b64_tr_b16 v[208:209], v232 offset:8192
    ds_read_b64_tr_b16 v[210:211], v232 offset:9216
    ds_read_b64_tr_b16 v[212:213], v232 offset:12288
    ds_read_b64_tr_b16 v[214:215], v232 offset:13312
    s_waitcnt vmcnt(6)
    s_xor_b32 s40, s86, 147456
    buffer_load_dwordx4 v230, s[88:91], s40 offen offset:2048 nt lds
    s_waitcnt lgkmcnt(6)
    v_mfma_f32_16x16x32_bf16 v[48:51], v[200:203], v[168:171], v[48:51]
    v_mfma_f32_16x16x32_bf16 v[52:55], v[200:203], v[172:175], v[52:55]
    s_waitcnt lgkmcnt(4)
    v_mfma_f32_16x16x32_bf16 v[48:51], v[204:207], v[176:179], v[48:51]
    v_mfma_f32_16x16x32_bf16 v[52:55], v[204:207], v[180:183], v[52:55]
    s_waitcnt lgkmcnt(2)
    v_mfma_f32_16x16x32_bf16 v[48:51], v[208:211], v[184:187], v[48:51]
    v_mfma_f32_16x16x32_bf16 v[52:55], v[208:211], v[188:191], v[52:55]
    s_waitcnt lgkmcnt(0)
    v_mfma_f32_16x16x32_bf16 v[48:51], v[212:215], v[192:195], v[48:51]
    v_mfma_f32_16x16x32_bf16 v[52:55], v[212:215], v[196:199], v[52:55]
    ds_read_b128 v[168:171], v234 offset:24576
    ds_read_b128 v[172:175], v234 offset:24832
    ds_read_b128 v[176:179], v234 offset:25600
    ds_read_b128 v[180:183], v234 offset:25856
    ds_read_b128 v[184:187], v234 offset:26624
    ds_read_b128 v[188:191], v234 offset:26880
    ds_read_b128 v[192:195], v234 offset:27648
    ds_read_b128 v[196:199], v234 offset:27904
    s_waitcnt vmcnt(6)
    buffer_load_dwordx4 v231, s[88:91], s40 offen offset:3072 nt lds
    s_waitcnt vmcnt(5)
    s_add_u32 m0, s45, 49152
    s_xor_b32 s40, s86, 163840
    buffer_load_dwordx4 v230, s[24:27], s40 offen offset:0 nt lds
    s_waitcnt vmcnt(5)
    buffer_load_dwordx4 v231, s[24:27], s40 offen offset:1024 nt lds
    s_barrier
    ds_read_b64_tr_b16 v[200:201], v232 offset:16384
    ds_read_b64_tr_b16 v[202:203], v232 offset:17408
    ds_read_b64_tr_b16 v[204:205], v232 offset:20480
    ds_read_b64_tr_b16 v[206:207], v232 offset:21504
    ds_read_b64_tr_b16 v[208:209], v232 offset:24576
    ds_read_b64_tr_b16 v[210:211], v232 offset:25600
    ds_read_b64_tr_b16 v[212:213], v232 offset:28672
    ds_read_b64_tr_b16 v[214:215], v232 offset:29696
    buffer_load_dword v24, off, s[36:39], s55 sc1
    s_waitcnt vmcnt(6)
    s_xor_b32 s40, s86, 180224
    buffer_load_dwordx4 v230, s[88:91], s40 offen offset:2048 nt lds
    s_waitcnt lgkmcnt(6)
    v_mfma_f32_16x16x32_bf16 v[48:51], v[200:203], v[168:171], v[48:51]
    v_mfma_f32_16x16x32_bf16 v[52:55], v[200:203], v[172:175], v[52:55]
    s_waitcnt lgkmcnt(4)
    v_mfma_f32_16x16x32_bf16 v[48:51], v[204:207], v[176:179], v[48:51]
    v_mfma_f32_16x16x32_bf16 v[52:55], v[204:207], v[180:183], v[52:55]
    s_waitcnt lgkmcnt(2)
    v_mfma_f32_16x16x32_bf16 v[48:51], v[208:211], v[184:187], v[48:51]
    v_mfma_f32_16x16x32_bf16 v[52:55], v[208:211], v[188:191], v[52:55]
    s_waitcnt lgkmcnt(0)
    v_mfma_f32_16x16x32_bf16 v[48:51], v[212:215], v[192:195], v[48:51]
    v_mfma_f32_16x16x32_bf16 v[52:55], v[212:215], v[196:199], v[52:55]
    ds_read_b128 v[168:171], v234 offset:32768
    ds_read_b128 v[172:175], v234 offset:33024
    ds_read_b128 v[176:179], v234 offset:33792
    ds_read_b128 v[180:183], v234 offset:34048
    ds_read_b128 v[184:187], v234 offset:34816
    ds_read_b128 v[188:191], v234 offset:35072
    ds_read_b128 v[192:195], v234 offset:35840
    ds_read_b128 v[196:199], v234 offset:36096
    s_waitcnt vmcnt(6)
    buffer_load_dwordx4 v231, s[88:91], s40 offen offset:3072 nt lds
    s_waitcnt vmcnt(6)
    s_add_u32 m0, s45, 65536
    s_xor_b32 s40, s86, 196608
    buffer_load_dwordx4 v230, s[24:27], s40 offen offset:0 nt lds
    s_waitcnt vmcnt(6)
    buffer_load_dwordx4 v231, s[24:27], s40 offen offset:1024 nt lds
    s_barrier
    ds_read_b64_tr_b16 v[200:201], v232 offset:32768
    ds_read_b64_tr_b16 v[202:203], v232 offset:33792
    ds_read_b64_tr_b16 v[204:205], v232 offset:36864
    ds_read_b64_tr_b16 v[206:207], v232 offset:37888
    ds_read_b64_tr_b16 v[208:209], v232 offset:40960
    ds_read_b64_tr_b16 v[210:211], v232 offset:41984
    ds_read_b64_tr_b16 v[212:213], v232 offset:45056
    ds_read_b64_tr_b16 v[214:215], v232 offset:46080
    buffer_load_dword v25, off, s[36:39], s55 sc1
    s_waitcnt vmcnt(7)
    s_xor_b32 s40, s86, 212992
    buffer_load_dwordx4 v230, s[88:91], s40 offen offset:2048 nt lds
    s_waitcnt lgkmcnt(6)
    v_mfma_f32_16x16x32_bf16 v[48:51], v[200:203], v[168:171], v[48:51]
    v_mfma_f32_16x16x32_bf16 v[52:55], v[200:203], v[172:175], v[52:55]
    s_waitcnt lgkmcnt(4)
    v_mfma_f32_16x16x32_bf16 v[48:51], v[204:207], v[176:179], v[48:51]
    v_mfma_f32_16x16x32_bf16 v[52:55], v[204:207], v[180:183], v[52:55]
    s_waitcnt lgkmcnt(2)
    v_mfma_f32_16x16x32_bf16 v[48:51], v[208:211], v[184:187], v[48:51]
    v_mfma_f32_16x16x32_bf16 v[52:55], v[208:211], v[188:191], v[52:55]
    s_waitcnt lgkmcnt(0)
    v_mfma_f32_16x16x32_bf16 v[48:51], v[212:215], v[192:195], v[48:51]
    v_mfma_f32_16x16x32_bf16 v[52:55], v[212:215], v[196:199], v[52:55]
    ds_read_b128 v[168:171], v234 offset:40960
    ds_read_b128 v[172:175], v234 offset:41216
    ds_read_b128 v[176:179], v234 offset:41984
    ds_read_b128 v[180:183], v234 offset:42240
    ds_read_b128 v[184:187], v234 offset:43008
    ds_read_b128 v[188:191], v234 offset:43264
    ds_read_b128 v[192:195], v234 offset:44032
    ds_read_b128 v[196:199], v234 offset:44288
    s_waitcnt vmcnt(7)
    buffer_load_dwordx4 v231, s[88:91], s40 offen offset:3072 nt lds
    s_waitcnt vmcnt(6)
    s_add_u32 m0, s45, 0
    s_xor_b32 s40, s86, 229376
    buffer_load_dwordx4 v230, s[24:27], s40 offen offset:0 nt lds
    s_waitcnt vmcnt(6)
    buffer_load_dwordx4 v231, s[24:27], s40 offen offset:1024 nt lds
    s_barrier
    ds_read_b64_tr_b16 v[200:201], v232 offset:49152
    ds_read_b64_tr_b16 v[202:203], v232 offset:50176
    ds_read_b64_tr_b16 v[204:205], v232 offset:53248
    ds_read_b64_tr_b16 v[206:207], v232 offset:54272
    ds_read_b64_tr_b16 v[208:209], v232 offset:57344
    ds_read_b64_tr_b16 v[210:211], v232 offset:58368
    ds_read_b64_tr_b16 v[212:213], v232 offset:61440
    ds_read_b64_tr_b16 v[214:215], v232 offset:62464
    v_readfirstlane_b32 s61, v24
    s_cmp_eq_u32 s61, s60
    s_cselect_b32 s98, s38, 0
    buffer_load_dwordx4 v[20:23], v27, s[96:99], s19 offen sc1
    buffer_load_dwordx4 v[16:19], v26, s[96:99], s59 offen sc1
    s_waitcnt vmcnt(8)
    s_xor_b32 s40, s86, 245760
    buffer_load_dwordx4 v230, s[88:91], s40 offen offset:2048 nt lds
    s_waitcnt lgkmcnt(6)
    v_mfma_f32_16x16x32_bf16 v[48:51], v[200:203], v[168:171], v[48:51]
    v_mfma_f32_16x16x32_bf16 v[52:55], v[200:203], v[172:175], v[52:55]
    s_waitcnt lgkmcnt(4)
    v_mfma_f32_16x16x32_bf16 v[48:51], v[204:207], v[176:179], v[48:51]
    v_mfma_f32_16x16x32_bf16 v[52:55], v[204:207], v[180:183], v[52:55]
    s_waitcnt lgkmcnt(2)
    v_mfma_f32_16x16x32_bf16 v[48:51], v[208:211], v[184:187], v[48:51]
    v_mfma_f32_16x16x32_bf16 v[52:55], v[208:211], v[188:191], v[52:55]
    s_waitcnt lgkmcnt(0)
    v_mfma_f32_16x16x32_bf16 v[48:51], v[212:215], v[192:195], v[48:51]
    v_mfma_f32_16x16x32_bf16 v[52:55], v[212:215], v[196:199], v[52:55]
    ds_read_b128 v[168:171], v234 offset:49152
    ds_read_b128 v[172:175], v234 offset:49408
    ds_read_b128 v[176:179], v234 offset:50176
    ds_read_b128 v[180:183], v234 offset:50432
    ds_read_b128 v[184:187], v234 offset:51200
    ds_read_b128 v[188:191], v234 offset:51456
    ds_read_b128 v[192:195], v234 offset:52224
    ds_read_b128 v[196:199], v234 offset:52480
    s_waitcnt vmcnt(8)
    buffer_load_dwordx4 v231, s[88:91], s40 offen offset:3072 nt lds
    s_waitcnt vmcnt(6)
    s_barrier
    ds_read_b64_tr_b16 v[200:201], v233 offset:0
    ds_read_b64_tr_b16 v[202:203], v233 offset:1024
    ds_read_b64_tr_b16 v[204:205], v233 offset:4096
    ds_read_b64_tr_b16 v[206:207], v233 offset:5120
    ds_read_b64_tr_b16 v[208:209], v233 offset:8192
    ds_read_b64_tr_b16 v[210:211], v233 offset:9216
    ds_read_b64_tr_b16 v[212:213], v233 offset:12288
    ds_read_b64_tr_b16 v[214:215], v233 offset:13312
    s_cmp_eq_u32 s61, s60
    s_cbranch_scc0 L_again
L_againback:
    s_waitcnt lgkmcnt(6)
    v_mfma_f32_16x16x32_bf16 v[48:51], v[200:203], v[168:171], v[48:51]
    v_mfma_f32_16x16x32_bf16 v[52:55], v[200:203], v[172:175], v[52:55]
    s_waitcnt lgkmcnt(4)
    v_mfma_f32_16x16x32_bf16 v[48:51], v[204:207], v[176:179], v[48:51]
    v_mfma_f32_16x16x32_bf16 v[52:55], v[204:207], v[180:183], v[52:55]
    s_waitcnt lgkmcnt(2)
    v_mfma_f32_16x16x32_bf16 v[48:51], v[208:211], v[184:187], v[48:51]
    v_mfma_f32_16x16x32_bf16 v[52:55], v[208:211], v[188:191], v[52:55]
    s_waitcnt lgkmcnt(0)
    v_mfma_f32_16x16x32_bf16 v[48:51], v[212:215], v[192:195], v[48:51]
    v_mfma_f32_16x16x32_bf16 v[52:55], v[212:215], v[196:199], v[52:55]
    ds_read_b128 v[168:171], v234 offset:57344
    ds_read_b128 v[172:175], v234 offset:57600
    ds_read_b128 v[176:179], v234 offset:58368
    ds_read_b128 v[180:183], v234 offset:58624
    ds_read_b128 v[184:187], v234 offset:59392
    ds_read_b128 v[188:191], v234 offset:59648
    ds_read_b128 v[192:195], v234 offset:60416
    ds_read_b128 v[196:199], v234 offset:60672
    s_cmp_eq_u32 s61, s60
    s_cbranch_scc0 L_nofac
    s_waitcnt vmcnt(2)
    v_lshlrev_b32 v12, 16, v16
    v_and_b32 v13, 0xffff0000, v16
    v_lshlrev_b32 v14, 16, v17
    v_and_b32 v15, 0xffff0000, v17
    v_lshlrev_b32 v16, 16, v18
    v_and_b32 v17, 0xffff0000, v18
    v_lshlrev_b32 v18, 16, v19
    v_and_b32 v19, 0xffff0000, v19
    v_max_f32 v34, v8, v20
    v_max_f32 v35, v10, v22
    v_sub_f32 v32, v8, v34
    v_sub_f32 v36, v20, v34
    v_sub_f32 v33, v10, v35
    v_sub_f32 v37, v22, v35
    v_exp_f32 v32, v32
    v_exp_f32 v36, v36
    v_exp_f32 v33, v33
    v_exp_f32 v37, v37
    s_nop 0
    v_mul_f32 v34, v9, v32
    v_mul_f32 v35, v11, v33
    v_fma_f32 v34, v21, v36, v34
    v_fma_f32 v35, v23, v37, v35
    v_rcp_f32 v34, v34
    v_rcp_f32 v35, v35
    s_nop 0
    v_mul_f32 v32, v32, v34
    v_mul_f32 v36, v36, v34
    v_mul_f32 v33, v33, v35
    v_mul_f32 v37, v37, v35
    v_mul_f32 v12, v12, v36
    v_mul_f32 v13, v13, v36
    v_mul_f32 v14, v14, v36
    v_mul_f32 v15, v15, v36
    v_mul_f32 v16, v16, v37
    v_mul_f32 v17, v17, v37
    v_mul_f32 v18, v18, v37
    v_mul_f32 v19, v19, v37
L_nofac:
    s_waitcnt vmcnt(0)
    s_barrier
    ds_read_b64_tr_b16 v[200:201], v232 offset:0
    ds_read_b64_tr_b16 v[202:203], v232 offset:1024
    ds_read_b64_tr_b16 v[204:205], v232 offset:4096
    ds_read_b64_tr_b16 v[206:207], v232 offset:5120
    ds_read_b64_tr_b16 v[208:209], v232 offset:8192
    ds_read_b64_tr_b16 v[210:211], v232 offset:9216
    ds_read_b64_tr_b16 v[212:213], v232 offset:12288
    ds_read_b64_tr_b16 v[214:215], v232 offset:13312
    s_waitcnt lgkmcnt(6)
    v_mfma_f32_16x16x32_bf16 v[48:51], v[200:203], v[168:171], v[48:51]
    v_mfma_f32_16x16x32_bf16 v[52:55], v[200:203], v[172:175], v[52:55]
    s_waitcnt lgkmcnt(4)
    v_mfma_f32_16x16x32_bf16 v[48:51], v[204:207], v[176:179], v[48:51]
    v_mfma_f32_16x16x32_bf16 v[52:55], v[204:207], v[180:183], v[52:55]
    s_waitcnt lgkmcnt(2)
    v_mfma_f32_16x16x32_bf16 v[48:51], v[208:211], v[184:187], v[48:51]
    v_mfma_f32_16x16x32_bf16 v[52:55], v[208:211], v[188:191], v[52:55]
    s_waitcnt lgkmcnt(0)
    v_mfma_f32_16x16x32_bf16 v[48:51], v[212:215], v[192:195], v[48:51]
    v_mfma_f32_16x16x32_bf16 v[52:55], v[212:215], v[196:199], v[52:55]
    s_cmp_eq_u32 s61, s60
    s_cbranch_scc0 L_late
    s_nop 4
L_fin:
    v_pk_fma_f32 v[12:13], v[48:49], v[32:33], v[12:13] op_sel_hi:[1,0,1]
    v_pk_fma_f32 v[14:15], v[50:51], v[32:33], v[14:15] op_sel_hi:[1,0,1]
    v_pk_fma_f32 v[16:17], v[52:53], v[32:33], v[16:17] op_sel:[0,1,0]
    v_pk_fma_f32 v[18:19], v[54:55], v[32:33], v[18:19] op_sel:[0,1,0]
    v_cvt_pk_bf16_f32 v20, v12, v13
    v_cvt_pk_bf16_f32 v21, v14, v15
    v_cvt_pk_bf16_f32 v22, v16, v17
    v_cvt_pk_bf16_f32 v23, v18, v19
    s_nop 1
    v_permlane16_swap_b32 v20, v22
    v_permlane16_swap_b32 v21, v23
    buffer_store_dwordx4 v[20:23], v28, s[32:35], 0 offen
L_end:
    s_endpgm
L_pubfar:
    buffer_store_dwordx4 v[40:43], v26, s[36:39], s58 offen sc1
    buffer_store_dwordx4 v[8:11], v31, s[36:39], s43 offen sc1
    s_branch L_pubback
L_flagfar:
    buffer_store_dword v32, v29, s[36:39], s54 offen sc1
    s_cmp_lg_u32 s42, 0
    s_cbranch_scc1 L_dbgback
L_dbgflag:
    s_cmp_lg_u32 s3, 0
    s_cbranch_scc1 L_dbgback
    v_mov_b32 v34, s2
    v_mov_b32 v35, 1
    s_mov_b64 exec, 1
    global_store_byte v34, v35, s[12:13] sc1
    s_mov_b64 exec, -1
    s_branch L_dbgback
L_again:
    v_readfirstlane_b32 s47, v25
    s_cmp_eq_u32 s47, s60
    s_cselect_b32 s98, s38, 0
    buffer_load_dwordx4 v[20:23], v27, s[96:99], s19 offen sc1
    buffer_load_dwordx4 v[16:19], v26, s[96:99], s59 offen sc1
    s_branch L_againback
L_late:
    s_cmp_eq_u32 s47, s60
    s_cbranch_scc1 L_got2
L_spin:
    v_mov_b32 v32, s18
    buffer_load_dword v24, off, s[36:39], s55 sc1
    global_load_ubyte v25, v32, s[12:13] sc1
    s_add_u32 s62, s62, 1
    s_waitcnt vmcnt(0)
    v_readfirstlane_b32 s61, v24
    v_readfirstlane_b32 s47, v25
    s_cmp_eq_u32 s61, s60
    s_cbranch_scc1 L_got
    s_cmp_lg_u32 s47, 0
    s_cbranch_scc1 L_got
    s_sleep 1
    s_cmp_lt_u32 s62, 0x200000
    s_cbranch_scc1 L_spin
L_got:
    buffer_load_dwordx4 v[20:23], v27, s[36:39], s19 offen sc1
    buffer_load_dwordx4 v[16:19], v26, s[36:39], s59 offen sc1
L_got2:
    s_waitcnt vmcnt(0)
    v_lshlrev_b32 v12, 16, v16
    v_and_b32 v13, 0xffff0000, v16
    v_lshlrev_b32 v14, 16, v17
    v_and_b32 v15, 0xffff0000, v17
    v_lshlrev_b32 v16, 16, v18
    v_and_b32 v17, 0xffff0000, v18
    v_lshlrev_b32 v18, 16, v19
    v_and_b32 v19, 0xffff0000, v19
    v_max_f32 v34, v8, v20
    v_max_f32 v35, v10, v22
    v_sub_f32 v32, v8, v34
    v_sub_f32 v36, v20, v34
    v_sub_f32 v33, v10, v35
    v_sub_f32 v37, v22, v35
    v_exp_f32 v32, v32
    v_exp_f32 v36, v36
    v_exp_f32 v33, v33
    v_exp_f32 v37, v37
    s_nop 0
    v_mul_f32 v34, v9, v32
    v_mul_f32 v35, v11, v33
    v_fma_f32 v34, v21, v36, v34
    v_fma_f32 v35, v23, v37, v35
    v_rcp_f32 v34, v34
    v_rcp_f32 v35, v35
    s_nop 0
    v_mul_f32 v32, v32, v34
    v_mul_f32 v36, v36, v34
    v_mul_f32 v33, v33, v35
    v_mul_f32 v37, v37, v35
    v_mul_f32 v12, v12, v36
    v_mul_f32 v13, v13, v36
    v_mul_f32 v14, v14, v36
    v_mul_f32 v15, v15, v36
    v_mul_f32 v16, v16, v37
    v_mul_f32 v17, v17, v37
    v_mul_f32 v18, v18, v37
    v_mul_f32 v19, v19, v37
    s_branch L_fin
L_end2:
    s_endpgm
.section .rodata,"a"
.p2align 6
.amdhsa_kernel standalone__gqa_softmax__sampling_kernel
  .amdhsa_next_free_vgpr 252
  .amdhsa_next_free_sgpr 100
  .amdhsa_accum_offset 252
  .amdhsa_group_segment_fixed_size 0
  .amdhsa_kernarg_size 48
  .amdhsa_user_sgpr_count 2
  .amdhsa_user_sgpr_kernarg_segment_ptr 1
  .amdhsa_system_sgpr_workgroup_id_x 1
.end_amdhsa_kernel
```
